```python
import torch

def _softmax(x, axis=-1):
    return torch.softmax(x, dim=axis)
def _gelu(x):
    return torch.nn.functional.gelu(x, approximate="tanh")
def _silu(x):
    return torch.nn.functional.silu(x)
def _sigmoid(x):
    return torch.sigmoid(x)
def _layernorm(x, axis=-1, eps=1e-5):
    m = x.mean(dim=axis, keepdim=True)
    v = x.var(dim=axis, keepdim=True, unbiased=False)
    return (x - m) / torch.sqrt(v + eps)
def _scatter_add(tgt, idx, src, axis=0):
    return tgt.clone().index_add_(axis, idx, src)
def _segment_sum(src, seg, n):
    out = torch.zeros((n,) + src.shape[1:], dtype=src.dtype)
    return out.index_add_(0, seg, src)
def _pad(x, pw):
    flat = tuple(v for pair in reversed(pw) for v in pair)
    return torch.nn.functional.pad(x, flat)

kernel_name = 'sequential_preLN__compressed_kv_cla__moe_arch_mod__decode'

def setup_inputs():

    _w = (lambda a: (lambda t: t.to(torch.bfloat16) if t.is_floating_point() else t)(torch.as_tensor(a)))
    def _A_setup():
        B, H, Sq, Sk, D, M = 1, 32, 1, 8192, 128, 512
        Dc = 4 * D
        return {
            "x": _w((lambda *s: torch.randn(*s, dtype=torch.bfloat16) * 0.05)(B, Sq, M)),
            "c_kv": _w((lambda *s: torch.randn(*s, dtype=torch.bfloat16) * 0.4)(B, Sk, Dc)),
            "w_q": _w((lambda *s: torch.randn(*s, dtype=torch.bfloat16) * 3.2)(M, H, D) * (M ** -0.5)),
            "w_uk": _w((lambda *s: torch.randn(*s, dtype=torch.bfloat16) * 3.2)(Dc, H, D) * (Dc ** -0.5)),
            "w_uv": _w((lambda *s: torch.randn(*s, dtype=torch.bfloat16) * 0.4)(Dc, H, D) * (Dc ** -0.5)),
            "w_o": _w((lambda *s: torch.randn(*s, dtype=torch.bfloat16) * 0.4)(H, D, M) * ((H * D) ** -0.5)),
        }
    _A_in = _A_setup()

    def _B_setup():
        B, S, D, F, C = 1, 1, 512, 1376, 1
        return {
            "x": _w((lambda *s: torch.randn(*s, dtype=torch.bfloat16) * 0.05)(B, S, D)),
            "w_r": _w((lambda *s: torch.randn(*s, dtype=torch.bfloat16) * 0.1)(D)),
            "w_gate": _w((lambda *s: torch.randn(*s, dtype=torch.bfloat16) * 0.05)(D, F)),
            "w_up": _w((lambda *s: torch.randn(*s, dtype=torch.bfloat16) * 0.05)(D, F)),
            "w_down": _w((lambda *s: torch.randn(*s, dtype=torch.bfloat16) * 0.05)(F, D)),
        }
    _B_in = _B_setup()

    return {
        "A_x": _A_in["x"],
        "A_c_kv": _A_in["c_kv"],
        "A_w_q": _A_in["w_q"],
        "A_w_uk": _A_in["w_uk"],
        "A_w_uv": _A_in["w_uv"],
        "A_w_o": _A_in["w_o"],
        "B_x": _B_in["x"],
        "B_w_r": _B_in["w_r"],
        "B_w_gate": _B_in["w_gate"],
        "B_w_up": _B_in["w_up"],
        "B_w_down": _B_in["w_down"],
    }

def reference(A_x, A_c_kv, A_w_q, A_w_uk, A_w_uv, A_w_o, B_x, B_w_r, B_w_gate, B_w_up, B_w_down):
    def _A_ref(x, c_kv, w_q, w_uk, w_uv, w_o):
        B, Sq, M = x.shape[0], x.shape[1], x.shape[2]
        Sk = c_kv.shape[1]
        H, D = w_q.shape[1], w_q.shape[2]
        q = torch.einsum("bqm,mhd->bhqd", x, w_q)
        k = torch.einsum("bkc,chd->bhkd", c_kv, w_uk)
        v = torch.einsum("bkc,chd->bhkd", c_kv, w_uv)
        scores = torch.einsum("bhqd,bhkd->bhqk", q, k) * (D ** -0.5)
        off = Sk - Sq
        qi = torch.arange(Sq)[:, None]
        kj = torch.arange(Sk)[None, :]
        cmask = kj <= (qi + off)
        scores = torch.where(cmask[None, None], scores, -1e9)
        p = _softmax(scores, axis=-1)
        ctx = torch.einsum("bhqk,bhkd->bhqd", p, v)
        return torch.einsum("bhqd,hdm->bqm", ctx, w_o)

    def _B_ref(x, w_r, w_gate, w_up, w_down):
        B, S, D = x.shape
        C = 1
        r = x @ w_r
        idx = torch.argsort(-r, axis=-1)[:, :C]
        idx_e = (lambda x, n, axis: torch.repeat_interleave(x, n, dim=axis))(idx.reshape(B, C, 1), D, axis=2)
        x_sel = (lambda x, i, axis: torch.take_along_dim(x, i, dim=axis))(x, idx_e, axis=1)
        g = _silu(x_sel @ w_gate)
        u = x_sel @ w_up
        y = (g * u) @ w_down
        r_sel = _sigmoid((lambda x, i, axis: torch.take_along_dim(x, i, dim=axis))(r, idx, axis=1))
        y = y * r_sel.reshape(B, C, 1)
        b_off = (torch.arange(B) * S).reshape(B, 1)
        flat_idx = (idx + b_off).reshape(B * C)
        zero = (x * 0.0).reshape(B * S, D)
        upd = _scatter_add(zero, flat_idx, y.reshape(B * C, D), axis=0)
        return x + upd.reshape(B, S, D)

    x = A_x
    h = x + _A_ref(_layernorm(x, axis=-1), A_c_kv, A_w_q, A_w_uk, A_w_uv, A_w_o)
    h2 = h + _B_ref(_layernorm(h, axis=-1), B_w_r, B_w_gate, B_w_up, B_w_down)
    return h2
```

```asm
; @launch grid=(256,1,1) block=(512,1,1) lds=153600
.amdgcn_target "amdgcn-amd-amdhsa--gfx950"
.text
.p2align 12
.fill 832, 4, 0xbf810000
.globl sequential_preLN__compressed_kv_cla__moe_arch_mod__decode_kernel
.p2align 8
.type sequential_preLN__compressed_kv_cla__moe_arch_mod__decode_kernel,@function
sequential_preLN__compressed_kv_cla__moe_arch_mod__decode_kernel:
    s_load_dwordx2 s[8:9], s[0:1], 16
    s_load_dwordx2 s[4:5], s[0:1], 0
    s_load_dwordx2 s[12:13], s[0:1], 24
    s_load_dwordx2 s[24:25], s[0:1], 104
    s_load_dwordx2 s[28:29], s[0:1], 96
    v_lshrrev_b32 v2, 6, v0
    v_and_b32 v1, 63, v0
    s_and_b32 s37, s2, 7
    v_readfirstlane_b32 s36, v2
    s_lshr_b32 s38, s2, 3
    v_and_b32 v2, 15, v1
    v_lshrrev_b32 v3, 4, v1
    v_lshlrev_b32 v9, 4, v1
    s_mov_b32 s26, 7340032
    s_mov_b32 s27, 0x20000
    s_mov_b32 s10, 4194304
    s_mov_b32 s11, 0x20000
    s_mov_b32 s14, 4194304
    s_mov_b32 s15, 0x20000
    s_cmp_lt_u32 s2, 128
    s_cbranch_scc1 L_t1
    s_cmp_ge_u32 s2, 256
    s_cbranch_scc1 L_end0
    s_getpc_b64 s[44:45]
L_pc:
    v_lshlrev_b32 v4, 7, v0
    v_min_u32 v4, L_code_end-L_pc-4, v4
    s_lshl_b32 s46, s38, 2
    s_add_u32 s46, s46, s36
    s_cmp_ge_u32 s46, 67
    s_cbranch_scc1 L_nopf
    global_load_dword v36, v4, s[44:45]
L_nopf:
    s_load_dwordx2 s[16:17], s[0:1], 8
    s_cmp_lg_u32 s36, 4
    s_cbranch_scc1 L_team2
    s_and_b32 s44, s2, 63
    s_lshl_b32 s44, s44, 7
    s_and_b32 s46, s38, 1
    s_lshl_b32 s45, s46, 13
    s_add_u32 s44, s44, s45
    s_add_u32 s44, s44, 327680
    s_xor_b32 s45, s44, 8192
    s_and_b32 s3, s38, 15
    s_lshl_b32 s47, s3, 18
    s_lshl_b32 s48, s37, 10
    s_add_u32 s47, s47, s48
    s_lshl_b32 s48, s37, 13
    s_lshl_b32 s49, s3, 9
    s_add_u32 s48, s48, s49
    s_add_u32 s48, s48, 196608
    v_lshlrev_b32 v13, 13, v1
    v_lshlrev_b32 v8, 7, v1
    s_cmp_lt_u32 s38, 26
    s_mov_b64 exec, 0xff
    s_waitcnt lgkmcnt(0)
    s_cbranch_scc1 L_noprobe
    buffer_store_dwordx4 v[0:3], v9, s[24:27], s44 offen sc1
    buffer_store_dwordx4 v[0:3], v9, s[24:27], s45 offen sc1
L_noprobe:
    s_mov_b32 exec_lo, -1
    buffer_load_dword v35, v13, s[8:11], s47 offen offset:384
    s_mov_b32 exec_lo, 15
    buffer_load_dword v32, v8, s[24:27], s48 offen sc1
    s_cbranch_scc1 L_novote
    s_waitcnt vmcnt(3)
    s_mov_b32 exec_lo, 1
    s_mov_b32 s30, 256
    s_mov_b32 s31, 0x20000
    s_lshl_b32 s48, s37, 4
    s_add_u32 s3, s3, s48
    s_add_u32 s46, s46, 1
    v_mov_b32 v4, 0
    v_mov_b32 v5, s46
    s_getreg_b32 s45, hwreg(HW_REG_IB_STS, 0, 4)
    s_cmp_eq_u32 s45, 3
    s_cselect_b64 vcc, -1, 0
    v_cndmask_b32 v4, v4, v5, vcc
    buffer_store_byte v4, v9, s[28:31], s3 offen
L_novote:
    s_mov_b64 exec, -1
    s_branch L_team2
L_end0:
    s_endpgm
L_t1:
    s_mov_b32 s6, 1024
    s_mov_b32 s7, 0x20000
    s_lshr_b32 s44, s38, 2
    s_lshl_b32 s39, s37, 2
    s_add_u32 s39, s39, s44
    s_and_b32 s40, s38, 3
    v_lshlrev_b32 v4, 1, v3
    v_xor_b32 v4, v4, v2
    v_lshlrev_b32 v4, 4, v4
    v_lshl_or_b32 v4, v3, 13, v4
    v_xor_b32 v5, 0x80, v4
    s_lshl_b32 s46, s40, 20
    s_lshl_b32 s44, s39, 8
    s_add_u32 s46, s46, s44
    s_lshr_b32 s44, s36, 1
    s_and_b32 s45, s36, 1
    s_lshl_b32 s47, s44, 18
    s_lshl_b32 s48, s45, 15
    s_add_u32 s47, s47, s48
    s_add_u32 s47, s47, s46
    s_lshl_b32 s48, s36, 17
    s_add_u32 s48, s48, s46
    s_lshl_b32 s51, s36, 12
    s_add_u32 s51, s51, 22528
    s_mov_b32 m0, s51
    s_cmp_lg_u32 s36, 0
    s_waitcnt lgkmcnt(0)
    s_cbranch_scc1 L_t1_nox
    buffer_load_dwordx4 v[32:35], v9, s[4:7], 0 offen
L_t1_nox:
    buffer_load_dwordx4 v4, s[8:11], s47 offen offset:0 lds
    s_add_u32 s47, s47, 64512
    buffer_load_dwordx4 v5, s[8:11], s47 offen offset:1024 lds
    s_add_u32 s47, s47, 64512
    buffer_load_dwordx4 v4, s[8:11], s47 offen offset:2048 lds
    s_add_u32 s47, s47, 64512
    buffer_load_dwordx4 v5, s[8:11], s47 offen offset:3072 lds
    s_load_dword s41, s[24:25], 0
    s_add_u32 m0, s51, 32768
    s_mov_b32 s52, 0x10001
    s_mov_b32 s53, 0x10001
    v_lshrrev_b32 v12, 2, v1
    v_and_b32 v13, 7, v12
    v_xor_b32 v13, s36, v13
    v_lshlrev_b32 v13, 5, v13
    v_lshl_or_b32 v13, v12, 8, v13
    v_and_b32 v14, 3, v1
    v_lshl_or_b32 v12, v14, 3, v13
    v_and_b32 v13, 7, v2
    v_lshlrev_b32 v13, 1, v13
    v_xor_b32 v13, v13, v3
    v_lshlrev_b32 v13, 4, v13
    v_lshl_or_b32 v13, v2, 8, v13
    v_add_u32 v13, s51, v13
    v_xor_b32 v14, 64, v13
    v_xor_b32 v15, 0x80, v13
    v_xor_b32 v16, 0xc0, v13
    v_lshlrev_b32 v17, 4, v3
    s_lshl_b32 s44, s40, 8
    v_add_u32 v19, s44, v17
    s_lshl_b32 s54, s39, 11
    s_lshl_b32 s44, s40, 9
    s_lshl_b32 s45, s36, 6
    s_add_u32 s54, s54, 196608
    s_add_u32 s55, s54, s44
    s_add_u32 s55, s55, s45
    s_lshr_b32 s57, s39, 3
    s_lshl_b32 s57, s57, 14
    s_and_b32 s44, s39, 7
    s_lshl_b32 s44, s44, 10
    s_add_u32 s57, s57, s44
    s_lshl_b32 s44, s40, 8
    s_add_u32 s57, s57, s44
    s_add_u32 s57, s57, 65536
    s_add_u32 s61, s57, 8192
    s_lshl_b32 s58, s39, 17
    s_lshl_b32 s44, s40, 15
    s_add_u32 s58, s58, s44
    s_add_u32 s33, s58, 2097152
    s_add_u32 s44, s24, s33
    s_add_u32 s45, s24, 327680
    s_xor_b32 s44, s44, s45
    s_lshr_b32 s44, s44, 8
    s_and_b32 s63, s44, 8192
    s_lshl_b32 s45, s36, 5
    s_mov_b32 s60, 0x07060302
    v_lshl_add_u32 v20, v3, 3, s45
    v_and_b32 v18, 31, v1
    v_lshrrev_b32 v21, 5, v1
    v_lshlrev_b32 v6, 2, v21
    v_lshl_or_b32 v6, v18, 3, v6
    s_load_dwordx2 s[16:17], s[0:1], 8
    s_mov_b32 s18, 8388608
    s_mov_b32 s19, 0x20000
    v_lshrrev_b32 v130, 1, v1
    v_and_b32 v131, 1, v1
    v_lshlrev_b32 v131, 7, v131
    v_lshl_or_b32 v130, v130, 10, v131
    s_lshl_b32 s49, s37, 20
    s_lshr_b32 s44, s38, 1
    s_lshl_b32 s44, s44, 17
    s_add_u32 s49, s49, s44
    s_lshl_b32 s44, s36, 15
    s_add_u32 s49, s49, s44
    s_lshl_b32 s44, s38, 1
    s_add_u32 s44, s44, s36
    s_add_u32 s44, s44, 1
    s_and_b32 s44, s44, 3
    s_lshl_b32 s44, s44, 8
    s_add_u32 s49, s49, s44
    s_cmp_lg_u32 s36, 0
    s_cbranch_scc1 L_t1_noln
    s_waitcnt vmcnt(4)
    v_lshlrev_b32 v24, 16, v32
    v_and_b32 v25, 0xffff0000, v32
    v_lshlrev_b32 v26, 16, v33
    v_and_b32 v27, 0xffff0000, v33
    v_lshlrev_b32 v28, 16, v34
    v_and_b32 v29, 0xffff0000, v34
    v_lshlrev_b32 v30, 16, v35
    v_and_b32 v31, 0xffff0000, v35
    v_pk_add_f32 v[36:37], v[24:25], v[26:27]
    v_pk_add_f32 v[38:39], v[28:29], v[30:31]
    v_pk_add_f32 v[36:37], v[36:37], v[38:39]
    v_add_f32 v36, v36, v37
    s_nop 1
    v_add_f32_dpp v36, v36, v36 row_ror:8 row_mask:0xf bank_mask:0xf
    s_nop 1
    v_add_f32_dpp v36, v36, v36 row_ror:4 row_mask:0xf bank_mask:0xf
    s_nop 1
    v_add_f32_dpp v36, v36, v36 row_ror:2 row_mask:0xf bank_mask:0xf
    s_nop 1
    v_add_f32_dpp v36, v36, v36 row_ror:1 row_mask:0xf bank_mask:0xf
    v_mov_b32 v37, v36
    s_nop 1
    v_permlane16_swap_b32 v36, v37
    v_add_f32 v36, v36, v37
    v_mov_b32 v37, v36
    s_nop 1
    v_permlane32_swap_b32 v36, v37
    v_add_f32 v36, v36, v37
    v_mul_f32 v36, 0x3b000000, v36
    v_mov_b32 v38, 0
    v_sub_f32 v37, v24, v36
    v_fmac_f32 v38, v37, v37
    v_sub_f32 v37, v25, v36
    v_fmac_f32 v38, v37, v37
    v_sub_f32 v37, v26, v36
    v_fmac_f32 v38, v37, v37
    v_sub_f32 v37, v27, v36
    v_fmac_f32 v38, v37, v37
    v_sub_f32 v37, v28, v36
    v_fmac_f32 v38, v37, v37
    v_sub_f32 v37, v29, v36
    v_fmac_f32 v38, v37, v37
    v_sub_f32 v37, v30, v36
    v_fmac_f32 v38, v37, v37
    v_sub_f32 v37, v31, v36
    v_fmac_f32 v38, v37, v37
    s_nop 1
    v_add_f32_dpp v38, v38, v38 row_ror:8 row_mask:0xf bank_mask:0xf
    s_nop 1
    v_add_f32_dpp v38, v38, v38 row_ror:4 row_mask:0xf bank_mask:0xf
    s_nop 1
    v_add_f32_dpp v38, v38, v38 row_ror:2 row_mask:0xf bank_mask:0xf
    s_nop 1
    v_add_f32_dpp v38, v38, v38 row_ror:1 row_mask:0xf bank_mask:0xf
    v_mov_b32 v37, v38
    s_nop 1
    v_permlane16_swap_b32 v38, v37
    v_add_f32 v38, v38, v37
    v_mov_b32 v37, v38
    s_nop 1
    v_permlane32_swap_b32 v38, v37
    v_add_f32 v38, v38, v37
    v_mul_f32 v38, 0x3b000000, v38
    v_cvt_pk_bf16_f32 v36, v36, v36
    v_and_b32 v36, 0xffff0000, v36
    v_cvt_pk_bf16_f32 v38, v38, v38
    v_and_b32 v38, 0xffff0000, v38
    v_add_f32 v38, 0x3727c5ac, v38
    v_cvt_pk_bf16_f32 v38, v38, v38
    v_and_b32 v38, 0xffff0000, v38
    v_sqrt_f32 v38, v38
    v_sub_f32 v24, v24, v36
    v_sub_f32 v25, v25, v36
    v_sub_f32 v26, v26, v36
    v_sub_f32 v27, v27, v36
    v_sub_f32 v28, v28, v36
    v_sub_f32 v29, v29, v36
    v_sub_f32 v30, v30, v36
    v_sub_f32 v31, v31, v36
    v_cvt_pk_bf16_f32 v38, v38, v38
    v_and_b32 v38, 0xffff0000, v38
    v_rcp_f32 v38, v38
    v_cvt_pk_bf16_f32 v32, v24, v25
    v_cvt_pk_bf16_f32 v33, v26, v27
    v_cvt_pk_bf16_f32 v34, v28, v29
    v_cvt_pk_bf16_f32 v35, v30, v31
    v_lshlrev_b32 v24, 16, v32
    v_and_b32 v25, 0xffff0000, v32
    v_lshlrev_b32 v26, 16, v33
    v_and_b32 v27, 0xffff0000, v33
    v_lshlrev_b32 v28, 16, v34
    v_and_b32 v29, 0xffff0000, v34
    v_lshlrev_b32 v30, 16, v35
    v_and_b32 v31, 0xffff0000, v35
    v_mul_f32 v24, v24, v38
    v_mul_f32 v25, v25, v38
    v_mul_f32 v26, v26, v38
    v_mul_f32 v27, v27, v38
    v_mul_f32 v28, v28, v38
    v_mul_f32 v29, v29, v38
    v_mul_f32 v30, v30, v38
    v_mul_f32 v31, v31, v38
    v_cvt_pk_bf16_f32 v32, v24, v25
    v_cvt_pk_bf16_f32 v33, v26, v27
    v_cvt_pk_bf16_f32 v34, v28, v29
    v_cvt_pk_bf16_f32 v35, v30, v31
    ds_write_b128 v9, v[32:35] offset:0
L_t1_noln:
    v_lshlrev_b32 v29, 2, v1
    s_waitcnt lgkmcnt(0)
    s_add_u32 s41, s41, 1
    s_bitset1_b32 s41, 31
    s_mov_b32 s42, 0xff
    s_mov_b32 s43, 0x10001
    v_mov_b32 v22, s41
    s_and_b32 s44, s41, 1
    s_and_b32 s45, s41, 2
    s_lshl_b32 s45, s45, 15
    s_or_b32 s44, s44, s45
    v_and_b32 v10, 0xff, v22
    v_mov_b32 v11, s44
    v_xor_b32 v23, 0x10001, v11
    s_barrier
    ds_read_b128 v[32:35], v19 offset:0
    ds_read_b128 v[36:39], v19 offset:64
    ds_read_b128 v[40:43], v19 offset:128
    ds_read_b128 v[44:47], v19 offset:192
    buffer_load_dwordx4 v4, s[12:15], s48 offen offset:0 lds
    s_add_u32 s48, s48, 31744
    buffer_load_dwordx4 v5, s[12:15], s48 offen offset:1024 lds
    s_add_u32 s48, s48, 31744
    buffer_load_dwordx4 v4, s[12:15], s48 offen offset:2048 lds
    s_add_u32 s48, s48, 31744
    buffer_load_dwordx4 v5, s[12:15], s48 offen offset:3072 lds
    s_waitcnt vmcnt(4)
    s_barrier
    ds_read_b64_tr_b16 v[48:49], v12 offset:22528
    ds_read_b64_tr_b16 v[50:51], v12 offset:26624
    ds_read_b64_tr_b16 v[52:53], v12 offset:30720
    ds_read_b64_tr_b16 v[54:55], v12 offset:34816
    ds_read_b64_tr_b16 v[56:57], v12 offset:38912
    ds_read_b64_tr_b16 v[58:59], v12 offset:43008
    ds_read_b64_tr_b16 v[60:61], v12 offset:47104
    ds_read_b64_tr_b16 v[62:63], v12 offset:51200
    s_waitcnt lgkmcnt(6)
    v_mfma_f32_16x16x32_bf16 v[112:115], v[48:51], v[32:35], 0
    s_waitcnt lgkmcnt(4)
    v_mfma_f32_16x16x32_bf16 v[112:115], v[52:55], v[36:39], v[112:115]
    s_waitcnt lgkmcnt(2)
    v_mfma_f32_16x16x32_bf16 v[112:115], v[56:59], v[40:43], v[112:115]
    s_waitcnt lgkmcnt(0)
    v_mfma_f32_16x16x32_bf16 v[112:115], v[60:63], v[44:47], v[112:115]
    s_mov_b64 exec, s[52:53]
    s_nop 6
    v_bfi_b32 v112, s42, v10, v112
    v_bfi_b32 v113, s42, v10, v113
    v_bfi_b32 v114, s42, v10, v114
    v_bfi_b32 v115, s42, v10, v115
    buffer_store_dwordx4 v[112:115], v17, s[24:27], s55 offen
    s_mov_b64 exec, -1
    s_barrier
    s_cmp_lg_u32 s36, 0
    s_cbranch_scc1 L_a2_other
    s_lshl_b32 s44, s37, 4
    s_load_dwordx4 s[96:99], s[28:29], s44
    s_mov_b32 s50, 1048576
L_poll1:
    buffer_load_dwordx4 v[120:123], v9, s[24:27], s54 offen sc1
    buffer_load_dwordx4 v[124:127], v9, s[24:27], s54 offen offset:1024 sc1
    s_cmp_eq_u32 s50, 1048512
    s_cbranch_scc1 L_poll1_f
L_poll1_b:
    s_sub_u32 s50, s50, 1
    s_cbranch_scc1 L_poll1_x
    s_waitcnt vmcnt(1)
    v_xor_b32 v120, v120, v10
    v_xor_b32 v121, v121, v10
    v_xor_b32 v122, v122, v10
    v_xor_b32 v123, v123, v10
    v_or3_b32 v128, v120, v121, v122
    s_waitcnt vmcnt(0)
    v_xor_b32 v124, v124, v10
    v_xor_b32 v125, v125, v10
    v_xor_b32 v126, v126, v10
    v_xor_b32 v127, v127, v10
    v_or3_b32 v128, v128, v123, v124
    v_or3_b32 v128, v128, v125, v126
    v_bitop3_b32 v128, v128, s42, v127 bitop3:0xc8
    v_cmp_ne_u32 vcc, 0, v128
    s_nop 0
    s_and_b64 exec, vcc, vcc
    s_cbranch_scc1 L_poll1
L_poll1_x:
    s_mov_b64 exec, -1
    ds_read_b128 v[64:67], v13 offset:32768
    ds_read_b128 v[68:71], v14 offset:32768
    ds_read_b128 v[72:75], v15 offset:32768
    ds_read_b128 v[76:79], v16 offset:32768
    v_pk_add_f32 v[120:121], v[120:121], v[124:125]
    v_pk_add_f32 v[122:123], v[122:123], v[126:127]
    s_nop 1
    v_permlane32_swap_b32 v120, v122
    v_permlane32_swap_b32 v121, v123
    v_pk_add_f32 v[120:121], v[120:121], v[122:123]
    v_cvt_pk_bf16_f32 v120, v120, v121
    ds_write_b32 v6, v120 offset:1024
    s_waitcnt lgkmcnt(0)
L_a2_join:
    s_barrier
    ds_read_b128 v[32:35], v17 offset:1024
    ds_read_b128 v[36:39], v17 offset:1088
    ds_read_b128 v[40:43], v17 offset:1152
    ds_read_b128 v[44:47], v17 offset:1216
    s_waitcnt lgkmcnt(3)
    v_mfma_f32_16x16x32_bf16 v[116:119], v[64:67], v[32:35], 0
    s_waitcnt lgkmcnt(2)
    v_mfma_f32_16x16x32_bf16 v[116:119], v[68:71], v[36:39], v[116:119]
    s_waitcnt lgkmcnt(1)
    v_mfma_f32_16x16x32_bf16 v[116:119], v[72:75], v[40:43], v[116:119]
    s_waitcnt lgkmcnt(0)
    v_mfma_f32_16x16x32_bf16 v[116:119], v[76:79], v[44:47], v[116:119]
    s_mov_b64 exec, s[52:53]
    s_cmp_lg_u32 s36, 0
    s_nop 5
    v_perm_b32 v116, v117, v116, s60
    v_perm_b32 v117, v119, v118, s60
    ds_write_b64 v20, v[116:117] offset:1280
    s_mov_b64 exec, -1
    s_cbranch_scc1 L_qa_other
    s_lshl_b32 s97, s97, 2
    s_lshl_b32 s99, s99, 2
    s_or_b32 s96, s96, s97
    s_or_b32 s98, s98, s99
    s_lshl_b32 s98, s98, 4
    s_or_b32 s96, s96, s98
    s_and_b32 s97, s96, 0x55555555
    s_and_b32 s96, s96, 0xaaaaaaaa
    s_bcnt1_i32_b32 s97, s97
    s_bcnt1_i32_b32 s96, s96
    s_cmp_gt_u32 s96, s97
    s_cselect_b32 s100, 8192, 0
    s_waitcnt lgkmcnt(0)
    s_barrier
    ds_read_b32 v116, v29 offset:1280
    s_xor_b32 s63, s63, s100
    s_lshl_b32 s44, s63, 3
    s_and_b32 s45, s41, 1
    s_or_b32 s44, s44, s45
    v_mov_b32 v118, v11
    v_mov_b32 v120, s100
    v_mov_b32 v121, s63
    v_writelane_b32 v118, s44, 0
    s_waitcnt lgkmcnt(0)
    v_bfi_b32 v116, s43, v118, v116
    buffer_store_dword v116, v29, s[24:27], s57 offen sc1
    buffer_store_dword v116, v29, s[24:27], s61 offen sc1
    ds_write_b64 v17, v[120:121] offset:7168
L_qa_done:
    s_cmp_ge_u32 s36, 4
    s_barrier
    s_cbranch_scc1 L_noc1t
    buffer_load_dword v131, v130, s[16:19], s49 offen
L_noc1t:
    s_branch L_t1c
L_poll1_f:
    s_mov_b64 s[58:59], exec
    s_mov_b32 exec_lo, -1
    s_mov_b32 exec_hi, 0
    buffer_load_dwordx4 v[132:135], v9, s[24:27], s55 offen sc1
    s_waitcnt vmcnt(0)
    buffer_store_dwordx4 v[132:135], v9, s[24:27], s55 offen sc1
    s_mov_b64 exec, s[58:59]
    s_branch L_poll1_b
L_a2_other:
    s_waitcnt vmcnt(1)
    ds_read_b128 v[64:67], v13 offset:32768
    ds_read_b128 v[68:71], v14 offset:32768
    ds_read_b128 v[72:75], v15 offset:32768
    ds_read_b128 v[76:79], v16 offset:32768
    s_branch L_a2_join
L_qa_other:
    s_waitcnt lgkmcnt(0)
    s_barrier
    s_branch L_qa_done
.p2alignl 12, 0xbf810000
L_team2:
    s_sub_u32 s38, s38, 16
    s_lshl_b32 s44, s38, 18
    s_lshl_b32 s45, s37, 10
    s_add_u32 s55, s44, s45
    v_lshrrev_b32 v12, 3, v0
    v_and_b32 v13, 7, v0
    v_lshlrev_b32 v13, 7, v13
    v_lshl_or_b32 v12, v12, 13, v13
    v_lshlrev_b32 v8, 7, v1
    s_waitcnt lgkmcnt(0)
    s_load_dword s41, s[24:25], 0
    s_waitcnt lgkmcnt(0)
    s_cmp_ge_u32 s36, 4
    s_cbranch_scc1 L_noukpf
    buffer_load_dword v34, v12, s[12:15], s55 offen
L_noukpf:
    s_mov_b32 s18, 8388608
    s_mov_b32 s19, 0x20000
    s_lshr_b32 s44, s38, 1
    s_lshl_b32 s39, s37, 3
    s_add_u32 s39, s39, s44
    s_and_b32 s40, s38, 1
    v_lshlrev_b32 v4, 1, v3
    v_xor_b32 v4, v4, v2
    v_lshlrev_b32 v4, 4, v4
    v_lshl_or_b32 v4, v3, 10, v4
    v_xor_b32 v5, 0x80, v4
    s_lshl_b32 s47, s39, 17
    s_lshl_b32 s44, s36, 14
    s_add_u32 s47, s47, s44
    s_lshl_b32 s3, s40, 1
    s_lshr_b32 s46, s36, 1
    s_add_u32 s46, s46, s3
    s_lshl_b32 s51, s36, 12
    s_add_u32 s51, s51, 22528
    s_mul_i32 s44, s36, 2112
    v_add_u32 v18, s44, v9
    s_load_dwordx2 s[8:9], s[0:1], 64
    s_load_dwordx2 s[12:13], s[0:1], 72
    s_load_dwordx2 s[20:21], s[0:1], 80
    s_load_dwordx2 s[4:5], s[0:1], 40
    s_mov_b32 s6, 4194304
    s_mov_b32 s7, 0x20000
    s_mov_b32 s22, 1409024
    s_mov_b32 s23, 0x20000
    s_mov_b32 s10, 1409024
    s_mov_b32 s11, 0x20000
    s_mov_b32 s14, 1409024
    s_min_u32 s44, s37, 3
    s_mul_i32 s62, s37, 5
    s_add_u32 s62, s62, s44
    s_cmp_lt_u32 s37, 3
    s_cselect_b32 s63, 6, 5
    s_lshl_b32 s44, s63, 6
    s_sub_u32 s44, s44, 64
    v_and_b32 v6, 3, v1
    v_lshlrev_b32 v6, 7, v6
    v_min_u32 v6, s44, v6
    v_lshrrev_b32 v7, 2, v1
    v_mul_u32_u24 v7, 2752, v7
    v_add_u32 v6, v6, v7
    s_mul_i32 s61, s38, 88064
    s_lshl_b32 s44, s62, 6
    s_add_u32 s61, s61, s44
    s_add_u32 s41, s41, 1
    s_bitset1_b32 s41, 31
    s_mov_b32 s42, 0xff
    s_mov_b32 s43, 0x10001
    v_mov_b32 v22, s41
    s_and_b32 s44, s41, 1
    s_and_b32 s45, s41, 2
    s_lshl_b32 s45, s45, 15
    s_or_b32 s44, s44, s45
    v_and_b32 v10, 0xff, v22
    v_mov_b32 v11, s44
    v_xor_b32 v23, 0x10001, v11
    s_lshr_b32 s44, s36, 2
    s_add_u32 s44, s44, s3
    s_lshl_b32 s54, s44, 14
    s_and_b32 s44, s36, 3
    s_lshl_b32 s44, s44, 11
    s_add_u32 s54, s54, s44
    s_add_u32 s54, s54, 65536
    s_mov_b32 s34, 0x10001
    s_mov_b32 s35, 0x10001
    v_mov_b32 v61, 0x10000
    v_cndmask_b32 v60, 0, v61, s[34:35]
    s_lshl_b32 s44, s36, 3
    v_lshl_add_u32 v61, v3, 6, s44
    s_cmp_ge_u32 s36, 4
    s_cbranch_scc1 L_pv
    v_and_b32 v13, 7, v2
    v_lshlrev_b32 v13, 1, v13
    v_xor_b32 v13, v13, v3
    v_lshlrev_b32 v13, 4, v13
    v_lshl_or_b32 v13, v2, 8, v13
    s_lshl_b32 s44, s36, 13
    v_add_u32 v12, s44, v13
    v_mul_u32_u24 v17, 1056, v2
    v_lshl_add_u32 v17, v3, 4, v17
    s_add_u32 s57, s36, s3
    s_lshl_b32 s44, s36, 2
    v_lshlrev_b32 v20, 4, v2
    v_add_u32 v19, s44, v20
    s_lshl_b32 s44, s36, 10
    v_add_u32 v21, s44, v9
    v_lshlrev_b32 v58, 6, v2
    v_lshl_or_b32 v58, v3, 4, v58
    s_lshl_b32 s44, s36, 2
    v_add_u32 v59, s44, v58
    s_mov_b32 s55, 0x3e0293ee
    s_lshr_b32 s56, s39, 4
    s_lshl_b32 s56, s56, 14
    s_and_b32 s44, s39, 15
    s_lshl_b32 s44, s44, 9
    s_add_u32 s56, s56, s44
    s_lshl_b32 s44, s40, 8
    s_add_u32 s56, s56, s44
    s_add_u32 s56, s56, 131072
    v_lshl_or_b32 v56, v3, 13, v20
    s_add_u32 s44, s57, 0
    s_and_b32 s44, s44, 3
    s_lshl_b32 s45, s44, 15
    s_lshl_b32 s44, s44, 8
    v_add_u32 v13, s45, v12
    v_add_u32 v48, s44, v17
    v_xor_b32 v14, 64, v13
    v_xor_b32 v15, 0x80, v13
    v_xor_b32 v16, 0xc0, v13
    s_barrier
    s_add_u32 s44, s46, 0
    s_and_b32 s44, s44, 3
    s_lshl_b32 s45, s44, 15
    s_add_u32 m0, s51, s45
    s_lshl_b32 s44, s44, 8
    s_add_u32 s45, s47, s44
    s_add_u32 s48, s45, 0
    buffer_load_dwordx4 v4, s[16:19], s48 offen offset:0 lds
    s_add_u32 s48, s45, 3072
    buffer_load_dwordx4 v5, s[16:19], s48 offen offset:1024 lds
    s_add_u32 s48, s45, 6144
    buffer_load_dwordx4 v4, s[16:19], s48 offen offset:2048 lds
    s_add_u32 s48, s45, 9216
    buffer_load_dwordx4 v5, s[16:19], s48 offen offset:3072 lds
    s_barrier
    s_add_u32 s44, s46, 1
    s_and_b32 s44, s44, 3
    s_lshl_b32 s45, s44, 15
    s_add_u32 m0, s51, s45
    s_lshl_b32 s44, s44, 8
    s_add_u32 s45, s47, s44
    s_add_u32 s48, s45, 0
    buffer_load_dwordx4 v4, s[16:19], s48 offen offset:0 lds
    s_add_u32 s48, s45, 3072
    buffer_load_dwordx4 v5, s[16:19], s48 offen offset:1024 lds
    s_add_u32 s48, s45, 6144
    buffer_load_dwordx4 v4, s[16:19], s48 offen offset:2048 lds
    s_add_u32 s48, s45, 9216
    buffer_load_dwordx4 v5, s[16:19], s48 offen offset:3072 lds
    s_lshl_b32 s44, s37, 4
    s_load_dwordx4 s[96:99], s[28:29], s44
    s_waitcnt vmcnt(4)
    s_barrier
    ds_read_b128 v[64:67], v13 offset:22528
    ds_read_b128 v[68:71], v13 offset:26624
    ds_read_b128 v[72:75], v14 offset:22528
    ds_read_b128 v[76:79], v14 offset:26624
    ds_read_b128 v[80:83], v15 offset:22528
    ds_read_b128 v[84:87], v15 offset:26624
    ds_read_b128 v[88:91], v16 offset:22528
    ds_read_b128 v[92:95], v16 offset:26624
    s_add_u32 s44, s57, 1
    s_and_b32 s44, s44, 3
    s_lshl_b32 s45, s44, 15
    s_lshl_b32 s44, s44, 8
    v_add_u32 v13, s45, v12
    v_add_u32 v49, s44, v17
    v_xor_b32 v14, 64, v13
    v_xor_b32 v15, 0x80, v13
    v_xor_b32 v16, 0xc0, v13
    s_waitcnt lgkmcnt(0)
    s_lshl_b32 s97, s97, 2
    s_lshl_b32 s99, s99, 2
    s_or_b32 s96, s96, s97
    s_or_b32 s98, s98, s99
    s_lshl_b32 s98, s98, 4
    s_or_b32 s96, s96, s98
    s_and_b32 s97, s96, 0x55555555
    s_and_b32 s96, s96, 0xaaaaaaaa
    s_bcnt1_i32_b32 s97, s97
    s_bcnt1_i32_b32 s96, s96
    s_cmp_gt_u32 s96, s97
    s_cselect_b32 s100, 8192, 0
    s_add_u32 s54, s54, s100
    s_add_u32 s44, s46, 2
    s_and_b32 s44, s44, 3
    s_lshl_b32 s45, s44, 15
    s_add_u32 m0, s51, s45
    s_lshl_b32 s44, s44, 8
    s_add_u32 s45, s47, s44
    s_add_u32 s48, s45, 0
    buffer_load_dwordx4 v4, s[16:19], s48 offen offset:0 lds
    s_add_u32 s48, s45, 3072
    buffer_load_dwordx4 v5, s[16:19], s48 offen offset:1024 lds
    s_add_u32 s48, s45, 6144
    buffer_load_dwordx4 v4, s[16:19], s48 offen offset:2048 lds
    s_add_u32 s48, s45, 9216
    buffer_load_dwordx4 v5, s[16:19], s48 offen offset:3072 lds
    s_waitcnt vmcnt(4)
    s_barrier
    ds_read_b128 v[96:99], v13 offset:22528
    ds_read_b128 v[100:103], v13 offset:26624
    ds_read_b128 v[104:107], v14 offset:22528
    ds_read_b128 v[108:111], v14 offset:26624
    ds_read_b128 v[112:115], v15 offset:22528
    ds_read_b128 v[116:119], v15 offset:26624
    ds_read_b128 v[120:123], v16 offset:22528
    ds_read_b128 v[124:127], v16 offset:26624
    s_add_u32 s44, s57, 2
    s_and_b32 s44, s44, 3
    s_lshl_b32 s45, s44, 15
    s_lshl_b32 s44, s44, 8
    v_add_u32 v13, s45, v12
    v_add_u32 v50, s44, v17
    v_xor_b32 v14, 64, v13
    v_xor_b32 v15, 0x80, v13
    v_xor_b32 v16, 0xc0, v13
    s_add_u32 s44, s46, 3
    s_and_b32 s44, s44, 3
    s_lshl_b32 s45, s44, 15
    s_add_u32 m0, s51, s45
    s_lshl_b32 s44, s44, 8
    s_add_u32 s45, s47, s44
    s_add_u32 s48, s45, 0
    buffer_load_dwordx4 v4, s[16:19], s48 offen offset:0 lds
    s_add_u32 s48, s45, 3072
    buffer_load_dwordx4 v5, s[16:19], s48 offen offset:1024 lds
    s_add_u32 s48, s45, 6144
    buffer_load_dwordx4 v4, s[16:19], s48 offen offset:2048 lds
    s_add_u32 s48, s45, 9216
    buffer_load_dwordx4 v5, s[16:19], s48 offen offset:3072 lds
    s_waitcnt vmcnt(4)
    s_barrier
    ds_read_b128 v[128:131], v13 offset:22528
    ds_read_b128 v[132:135], v13 offset:26624
    ds_read_b128 v[136:139], v14 offset:22528
    ds_read_b128 v[140:143], v14 offset:26624
    ds_read_b128 v[144:147], v15 offset:22528
    ds_read_b128 v[148:151], v15 offset:26624
    ds_read_b128 v[152:155], v16 offset:22528
    ds_read_b128 v[156:159], v16 offset:26624
    s_mov_b32 s50, 1048576
    buffer_load_dwordx4 v[24:27], v9, s[24:27], s54 offen sc1
    buffer_load_dwordx4 v[28:31], v9, s[24:27], s54 offen offset:1024 sc1
    s_add_u32 s44, s57, 3
    s_and_b32 s44, s44, 3
    s_lshl_b32 s45, s44, 15
    s_lshl_b32 s44, s44, 8
    v_add_u32 v13, s45, v12
    v_add_u32 v51, s44, v17
    v_xor_b32 v14, 64, v13
    v_xor_b32 v15, 0x80, v13
    v_xor_b32 v16, 0xc0, v13
    s_waitcnt vmcnt(2)
    s_barrier
    ds_read_b128 v[160:163], v13 offset:22528
    ds_read_b128 v[164:167], v13 offset:26624
    ds_read_b128 v[168:171], v14 offset:22528
    ds_read_b128 v[172:175], v14 offset:26624
    ds_read_b128 v[176:179], v15 offset:22528
    ds_read_b128 v[180:183], v15 offset:26624
    ds_read_b128 v[184:187], v16 offset:22528
    ds_read_b128 v[188:191], v16 offset:26624
L_poll2_w:
    s_sub_u32 s50, s50, 1
    s_cbranch_scc1 L_poll2_x
    s_waitcnt vmcnt(1)
    v_bfe_u32 v34, v24, 16, 1
    v_bitop3_b32 v24, v24, v60, v23 bitop3:0xde
    v_xor_b32 v25, v25, v23
    v_xor_b32 v26, v26, v23
    v_xor_b32 v27, v27, v23
    v_bitop3_b32 v32, v24, v25, v26 bitop3:0x80
    ds_write_b128 v18, v[24:27] offset:0
    s_waitcnt vmcnt(0)
    v_bfe_u32 v35, v28, 16, 1
    v_bitop3_b32 v28, v28, v60, v23 bitop3:0xde
    v_xor_b32 v29, v29, v23
    v_xor_b32 v30, v30, v23
    v_xor_b32 v31, v31, v23
    v_bitop3_b32 v32, v32, v27, v28 bitop3:0x80
    ds_write_b128 v18, v[28:31] offset:1056
    v_bitop3_b32 v32, v32, v29, v30 bitop3:0x80
    v_bitop3_b32 v32, v32, s43, v31 bitop3:0x80
    v_cmp_ne_u32 vcc, s43, v32
    s_mov_b64 exec, s[34:35]
    ds_write_b64 v61, v[34:35] offset:21248
    s_mov_b64 exec, -1
    s_cbranch_vccnz L_poll2
L_poll2_x:
    s_waitcnt lgkmcnt(0)
    s_barrier
    ds_read_b128 v[192:195], v48 offset:0
    ds_read_b128 v[196:199], v48 offset:64
    ds_read_b128 v[200:203], v48 offset:128
    ds_read_b128 v[204:207], v48 offset:192
    ds_read_b128 v[208:211], v49 offset:0
    ds_read_b128 v[212:215], v49 offset:64
    ds_read_b128 v[216:219], v49 offset:128
    ds_read_b128 v[220:223], v49 offset:192
    ds_read_b128 v[224:227], v50 offset:0
    s_waitcnt lgkmcnt(8)
    v_mfma_f32_16x16x32_bf16 v[40:43], v[64:67], v[192:195], 0
    v_mfma_f32_16x16x32_bf16 v[44:47], v[68:71], v[192:195], 0
    ds_read_b128 v[228:231], v50 offset:64
    s_waitcnt lgkmcnt(8)
    v_mfma_f32_16x16x32_bf16 v[40:43], v[72:75], v[196:199], v[40:43]
    v_mfma_f32_16x16x32_bf16 v[44:47], v[76:79], v[196:199], v[44:47]
    ds_read_b128 v[232:235], v50 offset:128
    s_waitcnt lgkmcnt(8)
    v_mfma_f32_16x16x32_bf16 v[40:43], v[80:83], v[200:203], v[40:43]
    v_mfma_f32_16x16x32_bf16 v[44:47], v[84:87], v[200:203], v[44:47]
    ds_read_b128 v[236:239], v50 offset:192
    s_waitcnt lgkmcnt(8)
    v_mfma_f32_16x16x32_bf16 v[40:43], v[88:91], v[204:207], v[40:43]
    v_mfma_f32_16x16x32_bf16 v[44:47], v[92:95], v[204:207], v[44:47]
    ds_read_b128 v[240:243], v51 offset:0
    s_waitcnt lgkmcnt(8)
    v_mfma_f32_16x16x32_bf16 v[40:43], v[96:99], v[208:211], v[40:43]
    v_mfma_f32_16x16x32_bf16 v[44:47], v[100:103], v[208:211], v[44:47]
    ds_read_b128 v[244:247], v51 offset:64
    s_waitcnt lgkmcnt(8)
    v_mfma_f32_16x16x32_bf16 v[40:43], v[104:107], v[212:215], v[40:43]
    v_mfma_f32_16x16x32_bf16 v[44:47], v[108:111], v[212:215], v[44:47]
    ds_read_b128 v[248:251], v51 offset:128
    s_waitcnt lgkmcnt(8)
    v_mfma_f32_16x16x32_bf16 v[40:43], v[112:115], v[216:219], v[40:43]
    v_mfma_f32_16x16x32_bf16 v[44:47], v[116:119], v[216:219], v[44:47]
    ds_read_b128 v[252:255], v51 offset:192
    s_waitcnt lgkmcnt(8)
    v_mfma_f32_16x16x32_bf16 v[40:43], v[120:123], v[220:223], v[40:43]
    v_mfma_f32_16x16x32_bf16 v[44:47], v[124:127], v[220:223], v[44:47]
    s_waitcnt lgkmcnt(7)
    v_mfma_f32_16x16x32_bf16 v[40:43], v[128:131], v[224:227], v[40:43]
    v_mfma_f32_16x16x32_bf16 v[44:47], v[132:135], v[224:227], v[44:47]
    s_waitcnt lgkmcnt(6)
    v_mfma_f32_16x16x32_bf16 v[40:43], v[136:139], v[228:231], v[40:43]
    v_mfma_f32_16x16x32_bf16 v[44:47], v[140:143], v[228:231], v[44:47]
    s_waitcnt lgkmcnt(5)
    v_mfma_f32_16x16x32_bf16 v[40:43], v[144:147], v[232:235], v[40:43]
    v_mfma_f32_16x16x32_bf16 v[44:47], v[148:151], v[232:235], v[44:47]
    s_waitcnt lgkmcnt(4)
    v_mfma_f32_16x16x32_bf16 v[40:43], v[152:155], v[236:239], v[40:43]
    v_mfma_f32_16x16x32_bf16 v[44:47], v[156:159], v[236:239], v[44:47]
    s_waitcnt lgkmcnt(3)
    v_mfma_f32_16x16x32_bf16 v[40:43], v[160:163], v[240:243], v[40:43]
    v_mfma_f32_16x16x32_bf16 v[44:47], v[164:167], v[240:243], v[44:47]
    s_waitcnt lgkmcnt(2)
    v_mfma_f32_16x16x32_bf16 v[40:43], v[168:171], v[244:247], v[40:43]
    v_mfma_f32_16x16x32_bf16 v[44:47], v[172:175], v[244:247], v[44:47]
    s_waitcnt lgkmcnt(1)
    v_mfma_f32_16x16x32_bf16 v[40:43], v[176:179], v[248:251], v[40:43]
    v_mfma_f32_16x16x32_bf16 v[44:47], v[180:183], v[248:251], v[44:47]
    s_waitcnt lgkmcnt(0)
    v_mfma_f32_16x16x32_bf16 v[40:43], v[184:187], v[252:255], v[40:43]
    v_mfma_f32_16x16x32_bf16 v[44:47], v[188:191], v[252:255], v[44:47]
    s_nop 6
    v_max3_f32 v32, v40, v41, v42
    v_max3_f32 v32, v43, v44, v32
    v_max3_f32 v33, v45, v46, v47
    v_max_f32 v32, v32, v33
    v_mov_b32 v33, v32
    s_nop 1
    v_permlane16_swap_b32 v32, v33
    v_max_f32 v32, v32, v33
    v_mov_b32 v33, v32
    s_nop 1
    v_permlane32_swap_b32 v32, v33
    v_max_f32 v32, v32, v33
    v_mul_f32 v37, s55, v32
    ds_write_b32 v19, v37 offset:20992
    v_fma_f32 v40, v40, s55, -v37
    v_fma_f32 v41, v41, s55, -v37
    v_fma_f32 v42, v42, s55, -v37
    v_fma_f32 v43, v43, s55, -v37
    v_fma_f32 v44, v44, s55, -v37
    v_fma_f32 v45, v45, s55, -v37
    v_fma_f32 v46, v46, s55, -v37
    v_fma_f32 v47, v47, s55, -v37
    v_exp_f32 v40, v40
    v_exp_f32 v41, v41
    s_waitcnt lgkmcnt(0)
    s_barrier
    ds_read_b128 v[32:35], v20 offset:20992
    v_exp_f32 v42, v42
    v_exp_f32 v43, v43
    v_exp_f32 v44, v44
    v_exp_f32 v45, v45
    v_exp_f32 v46, v46
    v_exp_f32 v47, v47
    s_waitcnt lgkmcnt(0)
    v_max3_f32 v32, v32, v33, v34
    v_max_f32 v36, v32, v35
    v_sub_f32 v38, v37, v36
    v_exp_f32 v38, v38
    s_nop 0
    v_pk_mul_f32 v[40:41], v[40:41], v[38:39] op_sel_hi:[1,0]
    v_pk_mul_f32 v[42:43], v[42:43], v[38:39] op_sel_hi:[1,0]
    v_pk_mul_f32 v[44:45], v[44:45], v[38:39] op_sel_hi:[1,0]
    v_pk_mul_f32 v[46:47], v[46:47], v[38:39] op_sel_hi:[1,0]
    v_cvt_pk_bf16_f32 v32, v40, v41
    v_cvt_pk_bf16_f32 v33, v42, v43
    v_cvt_pk_bf16_f32 v34, v44, v45
    v_cvt_pk_bf16_f32 v35, v46, v47
    ds_write_b128 v21, v[32:35] offset:16896
    v_pk_add_f32 v[40:41], v[40:41], v[42:43]
    v_pk_add_f32 v[44:45], v[44:45], v[46:47]
    v_pk_add_f32 v[40:41], v[40:41], v[44:45]
    v_add_f32 v40, v40, v41
    ds_write_b32 v59, v40 offset:21504
    s_cmp_lg_u32 s36, 0
    s_waitcnt lgkmcnt(0)
    s_barrier
    s_cbranch_scc1 L_ffn
    ds_read_b128 v[40:43], v58 offset:21504
    v_xor_b32 v38, v36, v22
    s_waitcnt lgkmcnt(0)
    v_add_f32 v40, v40, v41
    v_add_f32 v42, v42, v43
    v_add_f32 v37, v40, v42
    v_mov_b32 v33, v37
    s_nop 1
    v_permlane16_swap_b32 v37, v33
    v_add_f32 v37, v37, v33
    v_mov_b32 v33, v37
    s_nop 1
    v_permlane32_swap_b32 v37, v33
    v_add_f32 v37, v37, v33
    v_xor_b32 v39, v37, v22
    s_mov_b32 exec_hi, 0
    buffer_store_dwordx4 v[36:39], v56, s[24:27], s56 offen sc1
    s_mov_b32 exec_hi, -1
    s_branch L_ffn
L_poll2:
    buffer_load_dwordx4 v[24:27], v9, s[24:27], s54 offen sc1
    buffer_load_dwordx4 v[28:31], v9, s[24:27], s54 offen offset:1024 sc1
    s_branch L_poll2_w
.p2alignl 12, 0xbf810000
L_pv:
    s_sub_u32 s57, s36, 4
    v_lshrrev_b32 v12, 2, v1
    v_and_b32 v13, 7, v12
    v_lshlrev_b32 v13, 5, v13
    v_lshl_or_b32 v13, v12, 8, v13
    v_and_b32 v14, 3, v1
    v_lshl_or_b32 v13, v14, 3, v13
    s_lshl_b32 s44, s57, 15
    v_add_u32 v12, s44, v13
    s_sub_u32 s60, s57, s3
    v_lshlrev_b32 v20, 3, v2
    v_lshl_or_b32 v20, v3, 19, v20
    s_lshl_b32 s55, s40, 21
    s_lshl_b32 s44, s57, 15
    s_add_u32 s55, s55, s44
    s_lshr_b32 s44, s39, 5
    s_lshl_b32 s44, s44, 14
    s_and_b32 s45, s39, 31
    s_lshl_b32 s45, s45, 8
    s_add_u32 s55, s55, s44
    s_add_u32 s55, s55, s45
    s_add_u32 s55, s55, 2097152
    s_xor_b32 s56, s55, 0x21000
    s_xor_b32 s58, s55, 0x44000
    s_xor_b32 s59, s55, 0x65000
    s_lshl_b32 s44, s57, 6
    v_lshl_add_u32 v21, v3, 4, s44
    s_mov_b32 s53, 0x07060302
    v_and_b32 v17, 7, v1
    v_lshlrev_b32 v17, 1, v17
    v_lshrrev_b32 v17, v17, v22
    v_lshlrev_b32 v44, 15, v17
    v_bfi_b32 v44, 1, v22, v44
    v_bitop3_b32 v44, v44, s43, v44 bitop3:0x80
    v_lshlrev_b32 v45, 14, v17
    v_bfi_b32 v45, 1, v22, v45
    v_bitop3_b32 v45, v45, s43, v45 bitop3:0x80
    s_sub_u32 s44, s60, 0
    s_and_b32 s44, s44, 3
    s_lshl_b32 s45, s44, 13
    s_lshl_b32 s44, s44, 10
    v_add_u32 v48, s45, v12
    v_add_u32 v13, s44, v9
    v_xor_b32 v49, 32, v48
    v_xor_b32 v50, 64, v48
    v_xor_b32 v51, 96, v48
    v_xor_b32 v52, 128, v48
    v_xor_b32 v53, 160, v48
    v_xor_b32 v54, 192, v48
    v_xor_b32 v55, 224, v48
    s_barrier
    s_add_u32 s44, s46, 0
    s_and_b32 s44, s44, 3
    s_lshl_b32 s45, s44, 15
    s_add_u32 m0, s51, s45
    s_lshl_b32 s44, s44, 8
    s_add_u32 s45, s47, s44
    s_add_u32 s48, s45, 0
    buffer_load_dwordx4 v4, s[16:19], s48 offen offset:0 lds
    s_add_u32 s48, s45, 3072
    buffer_load_dwordx4 v5, s[16:19], s48 offen offset:1024 lds
    s_add_u32 s48, s45, 6144
    buffer_load_dwordx4 v4, s[16:19], s48 offen offset:2048 lds
    s_add_u32 s48, s45, 9216
    buffer_load_dwordx4 v5, s[16:19], s48 offen offset:3072 lds
    s_barrier
    s_add_u32 s44, s46, 1
    s_and_b32 s44, s44, 3
    s_lshl_b32 s45, s44, 15
    s_add_u32 m0, s51, s45
    s_lshl_b32 s44, s44, 8
    s_add_u32 s45, s47, s44
    s_add_u32 s48, s45, 0
    buffer_load_dwordx4 v4, s[16:19], s48 offen offset:0 lds
    s_add_u32 s48, s45, 3072
    buffer_load_dwordx4 v5, s[16:19], s48 offen offset:1024 lds
    s_add_u32 s48, s45, 6144
    buffer_load_dwordx4 v4, s[16:19], s48 offen offset:2048 lds
    s_add_u32 s48, s45, 9216
    buffer_load_dwordx4 v5, s[16:19], s48 offen offset:3072 lds
    s_lshl_b32 s44, s37, 4
    s_load_dwordx4 s[96:99], s[28:29], s44
    s_waitcnt vmcnt(4)
    s_barrier
    ds_read_b64_tr_b16 v[64:65], v48 offset:22528
    ds_read_b64_tr_b16 v[66:67], v48 offset:26624
    ds_read_b64_tr_b16 v[80:81], v49 offset:22528
    ds_read_b64_tr_b16 v[82:83], v49 offset:26624
    ds_read_b64_tr_b16 v[96:97], v50 offset:22528
    ds_read_b64_tr_b16 v[98:99], v50 offset:26624
    ds_read_b64_tr_b16 v[112:113], v51 offset:22528
    ds_read_b64_tr_b16 v[114:115], v51 offset:26624
    ds_read_b64_tr_b16 v[128:129], v52 offset:22528
    ds_read_b64_tr_b16 v[130:131], v52 offset:26624
    ds_read_b64_tr_b16 v[144:145], v53 offset:22528
    ds_read_b64_tr_b16 v[146:147], v53 offset:26624
    ds_read_b64_tr_b16 v[160:161], v54 offset:22528
    ds_read_b64_tr_b16 v[162:163], v54 offset:26624
    ds_read_b64_tr_b16 v[176:177], v55 offset:22528
    ds_read_b64_tr_b16 v[178:179], v55 offset:26624
    s_sub_u32 s44, s60, 1
    s_and_b32 s44, s44, 3
    s_lshl_b32 s45, s44, 13
    s_lshl_b32 s44, s44, 10
    v_add_u32 v48, s45, v12
    v_add_u32 v14, s44, v9
    v_xor_b32 v49, 32, v48
    v_xor_b32 v50, 64, v48
    v_xor_b32 v51, 96, v48
    v_xor_b32 v52, 128, v48
    v_xor_b32 v53, 160, v48
    v_xor_b32 v54, 192, v48
    v_xor_b32 v55, 224, v48
    s_waitcnt lgkmcnt(0)
    s_lshl_b32 s97, s97, 2
    s_lshl_b32 s99, s99, 2
    s_or_b32 s96, s96, s97
    s_or_b32 s98, s98, s99
    s_lshl_b32 s98, s98, 4
    s_or_b32 s96, s96, s98
    s_and_b32 s97, s96, 0x55555555
    s_and_b32 s96, s96, 0xaaaaaaaa
    s_bcnt1_i32_b32 s97, s97
    s_bcnt1_i32_b32 s96, s96
    s_cmp_gt_u32 s96, s97
    s_cselect_b32 s100, 8192, 0
    s_add_u32 s54, s54, s100
    s_add_u32 s44, s46, 2
    s_and_b32 s44, s44, 3
    s_lshl_b32 s45, s44, 15
    s_add_u32 m0, s51, s45
    s_lshl_b32 s44, s44, 8
    s_add_u32 s45, s47, s44
    s_add_u32 s48, s45, 0
    buffer_load_dwordx4 v4, s[16:19], s48 offen offset:0 lds
    s_add_u32 s48, s45, 3072
    buffer_load_dwordx4 v5, s[16:19], s48 offen offset:1024 lds
    s_add_u32 s48, s45, 6144
    buffer_load_dwordx4 v4, s[16:19], s48 offen offset:2048 lds
    s_add_u32 s48, s45, 9216
    buffer_load_dwordx4 v5, s[16:19], s48 offen offset:3072 lds
    s_waitcnt vmcnt(4)
    s_barrier
    ds_read_b64_tr_b16 v[68:69], v48 offset:22528
    ds_read_b64_tr_b16 v[70:71], v48 offset:26624
    ds_read_b64_tr_b16 v[84:85], v49 offset:22528
    ds_read_b64_tr_b16 v[86:87], v49 offset:26624
    ds_read_b64_tr_b16 v[100:101], v50 offset:22528
    ds_read_b64_tr_b16 v[102:103], v50 offset:26624
    ds_read_b64_tr_b16 v[116:117], v51 offset:22528
    ds_read_b64_tr_b16 v[118:119], v51 offset:26624
    ds_read_b64_tr_b16 v[132:133], v52 offset:22528
    ds_read_b64_tr_b16 v[134:135], v52 offset:26624
    ds_read_b64_tr_b16 v[148:149], v53 offset:22528
    ds_read_b64_tr_b16 v[150:151], v53 offset:26624
    ds_read_b64_tr_b16 v[164:165], v54 offset:22528
    ds_read_b64_tr_b16 v[166:167], v54 offset:26624
    ds_read_b64_tr_b16 v[180:181], v55 offset:22528
    ds_read_b64_tr_b16 v[182:183], v55 offset:26624
    s_sub_u32 s44, s60, 2
    s_and_b32 s44, s44, 3
    s_lshl_b32 s45, s44, 13
    s_lshl_b32 s44, s44, 10
    v_add_u32 v48, s45, v12
    v_add_u32 v15, s44, v9
    v_xor_b32 v49, 32, v48
    v_xor_b32 v50, 64, v48
    v_xor_b32 v51, 96, v48
    v_xor_b32 v52, 128, v48
    v_xor_b32 v53, 160, v48
    v_xor_b32 v54, 192, v48
    v_xor_b32 v55, 224, v48
    s_add_u32 s44, s46, 3
    s_and_b32 s44, s44, 3
    s_lshl_b32 s45, s44, 15
    s_add_u32 m0, s51, s45
    s_lshl_b32 s44, s44, 8
    s_add_u32 s45, s47, s44
    s_add_u32 s48, s45, 0
    buffer_load_dwordx4 v4, s[16:19], s48 offen offset:0 lds
    s_add_u32 s48, s45, 3072
    buffer_load_dwordx4 v5, s[16:19], s48 offen offset:1024 lds
    s_add_u32 s48, s45, 6144
    buffer_load_dwordx4 v4, s[16:19], s48 offen offset:2048 lds
    s_add_u32 s48, s45, 9216
    buffer_load_dwordx4 v5, s[16:19], s48 offen offset:3072 lds
    s_waitcnt vmcnt(4)
    s_barrier
    ds_read_b64_tr_b16 v[72:73], v48 offset:22528
    ds_read_b64_tr_b16 v[74:75], v48 offset:26624
    ds_read_b64_tr_b16 v[88:89], v49 offset:22528
    ds_read_b64_tr_b16 v[90:91], v49 offset:26624
    ds_read_b64_tr_b16 v[104:105], v50 offset:22528
    ds_read_b64_tr_b16 v[106:107], v50 offset:26624
    ds_read_b64_tr_b16 v[120:121], v51 offset:22528
    ds_read_b64_tr_b16 v[122:123], v51 offset:26624
    ds_read_b64_tr_b16 v[136:137], v52 offset:22528
    ds_read_b64_tr_b16 v[138:139], v52 offset:26624
    ds_read_b64_tr_b16 v[152:153], v53 offset:22528
    ds_read_b64_tr_b16 v[154:155], v53 offset:26624
    ds_read_b64_tr_b16 v[168:169], v54 offset:22528
    ds_read_b64_tr_b16 v[170:171], v54 offset:26624
    ds_read_b64_tr_b16 v[184:185], v55 offset:22528
    ds_read_b64_tr_b16 v[186:187], v55 offset:26624
    s_mov_b32 s50, 1048576
    buffer_load_dwordx4 v[24:27], v9, s[24:27], s54 offen sc1
    buffer_load_dwordx4 v[28:31], v9, s[24:27], s54 offen offset:1024 sc1
    s_sub_u32 s44, s60, 3
    s_and_b32 s44, s44, 3
    s_lshl_b32 s45, s44, 13
    s_lshl_b32 s44, s44, 10
    v_add_u32 v48, s45, v12
    v_add_u32 v16, s44, v9
    v_xor_b32 v49, 32, v48
    v_xor_b32 v50, 64, v48
    v_xor_b32 v51, 96, v48
    v_xor_b32 v52, 128, v48
    v_xor_b32 v53, 160, v48
    v_xor_b32 v54, 192, v48
    v_xor_b32 v55, 224, v48
    s_waitcnt vmcnt(2)
    s_barrier
    ds_read_b64_tr_b16 v[76:77], v48 offset:22528
    ds_read_b64_tr_b16 v[78:79], v48 offset:26624
    ds_read_b64_tr_b16 v[92:93], v49 offset:22528
    ds_read_b64_tr_b16 v[94:95], v49 offset:26624
    ds_read_b64_tr_b16 v[108:109], v50 offset:22528
    ds_read_b64_tr_b16 v[110:111], v50 offset:26624
    ds_read_b64_tr_b16 v[124:125], v51 offset:22528
    ds_read_b64_tr_b16 v[126:127], v51 offset:26624
    ds_read_b64_tr_b16 v[140:141], v52 offset:22528
    ds_read_b64_tr_b16 v[142:143], v52 offset:26624
    ds_read_b64_tr_b16 v[156:157], v53 offset:22528
    ds_read_b64_tr_b16 v[158:159], v53 offset:26624
    ds_read_b64_tr_b16 v[172:173], v54 offset:22528
    ds_read_b64_tr_b16 v[174:175], v54 offset:26624
    ds_read_b64_tr_b16 v[188:189], v55 offset:22528
    ds_read_b64_tr_b16 v[190:191], v55 offset:26624
L_poll3_w:
    s_sub_u32 s50, s50, 1
    s_cbranch_scc1 L_poll3_x
    s_waitcnt vmcnt(1)
    v_bfe_u32 v34, v24, 16, 1
    v_bitop3_b32 v24, v24, v60, v23 bitop3:0xde
    v_xor_b32 v25, v25, v23
    v_xor_b32 v26, v26, v23
    v_xor_b32 v27, v27, v23
    v_bitop3_b32 v32, v24, v25, v26 bitop3:0x80
    ds_write_b128 v18, v[24:27] offset:0
    s_waitcnt vmcnt(0)
    v_bfe_u32 v35, v28, 16, 1
    v_bitop3_b32 v28, v28, v60, v23 bitop3:0xde
    v_xor_b32 v29, v29, v23
    v_xor_b32 v30, v30, v23
    v_xor_b32 v31, v31, v23
    v_bitop3_b32 v32, v32, v27, v28 bitop3:0x80
    ds_write_b128 v18, v[28:31] offset:1056
    v_bitop3_b32 v32, v32, v29, v30 bitop3:0x80
    v_bitop3_b32 v32, v32, s43, v31 bitop3:0x80
    v_cmp_ne_u32 vcc, s43, v32
    s_mov_b64 exec, s[34:35]
    ds_write_b64 v61, v[34:35] offset:21248
    s_mov_b64 exec, -1
    s_cbranch_vccnz L_poll3
L_poll3_x:
    s_waitcnt lgkmcnt(0)
    s_barrier
    s_lshl_b32 s44, s37, 19
    s_lshl_b32 s45, s38, 15
    s_add_u32 s44, s44, s45
    s_lshl_b32 s45, s57, 13
    s_add_u32 s44, s44, s45
    s_mov_b32 exec_lo, 0
    buffer_load_dword v7, v8, s[4:7], s44 offen
    s_mov_b64 exec, -1
    s_cmp_ge_u32 s57, 2
    s_cbranch_scc1 L_nogpre
    s_and_b32 s44, s57, 1
    s_mul_i32 s44, s44, 44032
    s_add_u32 s44, s44, s61
    s_bitcmp1_b32 s57, 1
    s_cbranch_scc1 L_gu4_u
    buffer_load_dword v7, v6, s[8:11], s44 offen
    s_branch L_gu4_e
L_gu4_u:
    buffer_load_dword v7, v6, s[12:15], s44 offen
L_gu4_e:
L_nogpre:
    ds_read_b128 v[40:43], v21 offset:21248
    s_waitcnt lgkmcnt(0)
    v_lshl_or_b32 v40, v40, 13, v20
    v_lshl_or_b32 v41, v41, 13, v20
    v_lshl_or_b32 v42, v42, 13, v20
    v_lshl_or_b32 v43, v43, 13, v20
    s_cmp_lg_u32 s57, 3
    s_cbranch_scc1 L_nopt
    v_xor_b32 v46, 8192, v40
    s_mov_b64 exec, 1
    buffer_load_dword v7, v46, s[24:27], s55 offen
    s_mov_b64 exec, -1
L_nopt:
    s_barrier
    s_barrier
    ds_read_b128 v[192:195], v13 offset:16896
    ds_read_b128 v[196:199], v14 offset:16896
    ds_read_b128 v[200:203], v15 offset:16896
    ds_read_b128 v[204:207], v16 offset:16896
    s_waitcnt lgkmcnt(3)
    v_mfma_f32_16x16x32_bf16 v[208:211], v[192:195], v[64:67], 0
    v_mfma_f32_16x16x32_bf16 v[212:215], v[192:195], v[80:83], 0
    s_waitcnt lgkmcnt(2)
    v_mfma_f32_16x16x32_bf16 v[208:211], v[196:199], v[68:71], v[208:211]
    v_mfma_f32_16x16x32_bf16 v[212:215], v[196:199], v[84:87], v[212:215]
    s_waitcnt lgkmcnt(1)
    v_mfma_f32_16x16x32_bf16 v[208:211], v[200:203], v[72:75], v[208:211]
    v_mfma_f32_16x16x32_bf16 v[212:215], v[200:203], v[88:91], v[212:215]
    s_waitcnt lgkmcnt(0)
    v_mfma_f32_16x16x32_bf16 v[208:211], v[204:207], v[76:79], v[208:211]
    v_mfma_f32_16x16x32_bf16 v[212:215], v[204:207], v[92:95], v[212:215]
    v_mfma_f32_16x16x32_bf16 v[216:219], v[192:195], v[96:99], 0
    v_mfma_f32_16x16x32_bf16 v[220:223], v[192:195], v[112:115], 0
    v_mfma_f32_16x16x32_bf16 v[216:219], v[196:199], v[100:103], v[216:219]
    v_mfma_f32_16x16x32_bf16 v[220:223], v[196:199], v[116:119], v[220:223]
    v_mfma_f32_16x16x32_bf16 v[216:219], v[200:203], v[104:107], v[216:219]
    v_mfma_f32_16x16x32_bf16 v[220:223], v[200:203], v[120:123], v[220:223]
    v_mfma_f32_16x16x32_bf16 v[216:219], v[204:207], v[108:111], v[216:219]
    v_mfma_f32_16x16x32_bf16 v[220:223], v[204:207], v[124:127], v[220:223]
    v_mfma_f32_16x16x32_bf16 v[224:227], v[192:195], v[128:131], 0
    v_perm_b32 v240, v212, v208, s53
    v_perm_b32 v244, v213, v209, s53
    v_mfma_f32_16x16x32_bf16 v[228:231], v[192:195], v[144:147], 0
    v_perm_b32 v248, v214, v210, s53
    v_perm_b32 v252, v215, v211, s53
    v_mfma_f32_16x16x32_bf16 v[224:227], v[196:199], v[132:135], v[224:227]
    v_bfi_b32 v240, s43, v44, v240
    v_bfi_b32 v244, s43, v44, v244
    v_mfma_f32_16x16x32_bf16 v[228:231], v[196:199], v[148:151], v[228:231]
    v_bfi_b32 v248, s43, v44, v248
    v_bfi_b32 v252, s43, v44, v252
    v_mfma_f32_16x16x32_bf16 v[224:227], v[200:203], v[136:139], v[224:227]
    v_perm_b32 v241, v220, v216, s53
    v_perm_b32 v245, v221, v217, s53
    v_mfma_f32_16x16x32_bf16 v[228:231], v[200:203], v[152:155], v[228:231]
    v_perm_b32 v249, v222, v218, s53
    v_perm_b32 v253, v223, v219, s53
    v_mfma_f32_16x16x32_bf16 v[224:227], v[204:207], v[140:143], v[224:227]
    v_bfi_b32 v241, s43, v45, v241
    v_bfi_b32 v245, s43, v45, v245
    v_mfma_f32_16x16x32_bf16 v[228:231], v[204:207], v[156:159], v[228:231]
    v_bfi_b32 v249, s43, v45, v249
    v_bfi_b32 v253, s43, v45, v253
    v_mfma_f32_16x16x32_bf16 v[232:235], v[192:195], v[160:163], 0
    buffer_store_dwordx2 v[240:241], v40, s[24:27], s55 offen offset:0 sc1
    v_mfma_f32_16x16x32_bf16 v[236:239], v[192:195], v[176:179], 0
    v_mfma_f32_16x16x32_bf16 v[232:235], v[196:199], v[164:167], v[232:235]
    buffer_store_dwordx2 v[244:245], v41, s[24:27], s56 offen offset:0 sc1
    v_mfma_f32_16x16x32_bf16 v[236:239], v[196:199], v[180:183], v[236:239]
    v_mfma_f32_16x16x32_bf16 v[232:235], v[200:203], v[168:171], v[232:235]
    buffer_store_dwordx2 v[248:249], v42, s[24:27], s58 offen offset:0 sc1
    v_mfma_f32_16x16x32_bf16 v[236:239], v[200:203], v[184:187], v[236:239]
    v_mfma_f32_16x16x32_bf16 v[232:235], v[204:207], v[172:175], v[232:235]
    buffer_store_dwordx2 v[252:253], v43, s[24:27], s59 offen offset:0 sc1
    v_mfma_f32_16x16x32_bf16 v[236:239], v[204:207], v[188:191], v[236:239]
    v_perm_b32 v242, v228, v224, s53
    v_perm_b32 v246, v229, v225, s53
    v_perm_b32 v250, v230, v226, s53
    v_perm_b32 v254, v231, v227, s53
    v_bfi_b32 v242, s43, v44, v242
    v_bfi_b32 v246, s43, v44, v246
    v_bfi_b32 v250, s43, v44, v250
    v_bfi_b32 v254, s43, v44, v254
    v_perm_b32 v243, v236, v232, s53
    v_bfi_b32 v243, s43, v45, v243
    buffer_store_dwordx2 v[242:243], v40, s[24:27], s55 offen offset:128 sc1
    v_perm_b32 v247, v237, v233, s53
    v_bfi_b32 v247, s43, v45, v247
    buffer_store_dwordx2 v[246:247], v41, s[24:27], s56 offen offset:128 sc1
    v_perm_b32 v251, v238, v234, s53
    v_bfi_b32 v251, s43, v45, v251
    buffer_store_dwordx2 v[250:251], v42, s[24:27], s58 offen offset:128 sc1
    v_perm_b32 v255, v239, v235, s53
    v_bfi_b32 v255, s43, v45, v255
    buffer_store_dwordx2 v[254:255], v43, s[24:27], s59 offen offset:128 sc1
    s_branch L_ffn
L_poll3:
    buffer_load_dwordx4 v[24:27], v9, s[24:27], s54 offen sc1
    buffer_load_dwordx4 v[28:31], v9, s[24:27], s54 offen offset:1024 sc1
    s_branch L_poll3_w
.p2alignl 12, 0xbf810000
L_t1c:
    s_mov_b32 s56, s33
    s_xor_b32 s58, s63, 8192
    s_add_u32 s58, s58, s33
    s_load_dwordx2 s[8:9], s[0:1], 32
    s_load_dwordx2 s[12:13], s[0:1], 40
    s_load_dwordx2 s[32:33], s[0:1], 88
    s_mov_b32 s34, 1024
    s_mov_b32 s35, 0x20000
    v_and_b32 v6, 0xff, v4
    v_lshl_or_b32 v6, v3, 17, v6
    v_xor_b32 v7, 0x80, v6
    s_lshr_b32 s44, s36, 1
    s_and_b32 s45, s36, 1
    s_lshl_b32 s49, s45, 13
    s_and_b32 s45, s44, 1
    s_lshl_b32 s45, s45, 16
    s_add_u32 s49, s49, s45
    s_lshr_b32 s44, s44, 1
    s_lshl_b32 s44, s44, 19
    s_add_u32 s49, s49, s44
    s_add_u32 s49, s49, s46
    s_mov_b32 s63, s38
    v_bfe_u32 v4, v1, 2, 2
    v_lshl_or_b32 v4, v3, 4, v4
    v_and_b32 v14, 3, v1
    v_lshlrev_b32 v5, 4, v14
    v_lshl_or_b32 v4, v4, 10, v5
    s_lshl_b32 s47, s37, 19
    s_lshl_b32 s44, s36, 16
    s_lshl_b32 s45, s63, 6
    s_add_u32 s47, s47, s44
    s_add_u32 s47, s47, s45
    v_lshl_add_u32 v8, v18, 1, s45
    s_and_b32 s44, s63, 1
    s_lshl_b32 s45, s44, 13
    s_add_u32 s47, s47, s45
    s_lshl_b32 s44, s44, 11
    s_add_u32 s62, s51, s44
    s_add_u32 s62, s62, 32768
    s_mov_b32 m0, s51
    v_lshlrev_b32 v125, 10, v1
    s_lshl_b32 s59, s38, 15
    s_lshl_b32 s45, s37, 19
    s_add_u32 s59, s59, s45
    s_mov_b32 s57, s55
    s_add_u32 s55, s55, 65536
    v_lshlrev_b32 v57, 9, v2
    v_lshl_or_b32 v57, v3, 14, v57
    v_lshlrev_b32 v123, 7, v1
    s_cmp_lg_u32 s36, 0
    s_waitcnt lgkmcnt(0)
    s_cbranch_scc1 L_c_small
    s_mov_b64 exec, 1
    buffer_load_dword v121, v9, s[24:27], s58 offen
    s_lshl_b32 s45, s39, 4
    s_add_u32 s45, s45, s100
    s_add_u32 s45, s45, 131072
    s_lshl_b32 s44, s38, 2
    s_lshl_b64 exec, 15, s44
    buffer_load_dword v121, v57, s[24:27], s45 offen sc1
    s_mov_b64 exec, 15
    buffer_load_dword v120, v123, s[24:27], s55 offen sc1
    s_mov_b64 exec, -1
    buffer_load_ushort v136, v8, s[4:7], 0 offen
    s_mov_b32 exec_hi, 0
    buffer_load_dword v122, v125, s[12:15], s59 offen offset:384
    buffer_load_dword v122, v125, s[12:15], s59 offen offset:256
    s_mov_b64 exec, -1
L_c_small:
    s_barrier
    s_add_u32 s48, s49, 0
    buffer_load_dwordx4 v6, s[8:11], s48 offen offset:0 lds
    s_add_u32 s48, s49, 15360
    buffer_load_dwordx4 v7, s[8:11], s48 offen offset:1024 lds
    s_add_u32 s48, s49, 30720
    buffer_load_dwordx4 v6, s[8:11], s48 offen offset:2048 lds
    s_add_u32 s48, s49, 46080
    buffer_load_dwordx4 v7, s[8:11], s48 offen offset:3072 lds
    s_mov_b32 m0, s62
    s_add_u32 s60, s47, 3072
    s_barrier
    buffer_load_dwordx4 v4, s[12:15], s47 offen lds
    buffer_load_dwordx4 v4, s[12:15], s60 offen offset:1024 lds
    s_xor_b32 s47, s47, 8192
    s_sub_u32 s62, s62, 22528
    s_xor_b32 s62, s62, 2048
    s_add_u32 s62, s62, 22528
    s_mov_b32 m0, s62
    s_add_u32 s60, s47, 3072
    s_barrier
    buffer_load_dwordx4 v4, s[12:15], s47 offen lds
    buffer_load_dwordx4 v4, s[12:15], s60 offen offset:1024 lds
    ds_read_b64 v[44:45], v17 offset:7168
    s_lshr_b32 s44, s36, 2
    s_lshl_b32 s44, s44, 14
    s_and_b32 s45, s36, 3
    s_lshl_b32 s45, s45, 11
    s_add_u32 s48, s56, s44
    s_add_u32 s48, s48, s45
    s_waitcnt lgkmcnt(0)
    v_readfirstlane_b32 s100, v44
    v_readfirstlane_b32 s44, v45
    s_nop 0
    s_add_u32 s48, s48, s44
    s_lshl_b32 s49, s39, 4
    s_add_u32 s49, s49, s100
    s_add_u32 s49, s49, 131072
    s_and_b32 s44, s39, 3
    s_lshl_b32 s44, s44, 6
    v_xor_b32 v19, s44, v29
    s_lshl_b32 s44, s36, 5
    v_lshl_add_u32 v20, v3, 2, s44
    v_lshrrev_b32 v46, 2, v1
    v_lshlrev_b32 v13, 3, v14
    v_lshl_or_b32 v13, v46, 6, v13
    v_add_u32 v13, s51, v13
    v_and_b32 v15, 1, v2
    v_lshlrev_b32 v15, 4, v15
    v_mov_b32 v16, 0xffff
    v_lshlrev_b32 v15, v15, v16
    v_lshrrev_b32 v16, 1, v2
    v_cmp_eq_u32 vcc, 0, v16
    s_nop 1
    v_cndmask_b32 v60, 0, v15, vcc
    v_cmp_eq_u32 vcc, 1, v16
    s_nop 1
    v_cndmask_b32 v61, 0, v15, vcc
    v_cmp_eq_u32 vcc, 2, v16
    s_nop 1
    v_cndmask_b32 v62, 0, v15, vcc
    v_cmp_eq_u32 vcc, 3, v16
    s_nop 1
    v_cndmask_b32 v63, 0, v15, vcc
    v_and_b32 v16, 3, v1
    v_lshlrev_b32 v16, 2, v16
    v_lshrrev_b32 v16, v16, v22
    v_lshlrev_b32 v72, 15, v16
    v_bfi_b32 v72, 1, v22, v72
    v_bitop3_b32 v72, v72, s43, v72 bitop3:0x04
    v_lshlrev_b32 v73, 14, v16
    v_bfi_b32 v73, 1, v22, v73
    v_bitop3_b32 v73, v73, s43, v73 bitop3:0x04
    v_lshlrev_b32 v74, 13, v16
    v_bfi_b32 v74, 1, v22, v74
    v_bitop3_b32 v74, v74, s43, v74 bitop3:0x04
    v_lshlrev_b32 v75, 12, v16
    v_bfi_b32 v75, 1, v22, v75
    v_bitop3_b32 v75, v75, s43, v75 bitop3:0x04
    s_mul_i32 s44, s36, 288
    v_lshl_add_u32 v16, v2, 4, s44
    v_lshl_add_u32 v16, v3, 3, v16
    v_lshl_add_u32 v16, v21, 13, v16
    v_and_b32 v15, 7, v2
    v_mul_u32_u24 v15, 288, v15
    v_add_u32 v15, v15, v17
    s_lshr_b32 s44, s36, 1
    s_lshl_b32 s45, s37, 2
    s_add_u32 s44, s44, s45
    s_lshl_b32 s61, s44, 11
    s_and_b32 s44, s36, 1
    s_lshl_b32 s44, s44, 8
    s_add_u32 s61, s61, s44
    s_add_u32 s61, s61, 262144
    v_bfe_u32 v132, v1, 2, 2
    v_lshlrev_b32 v132, 9, v132
    v_lshl_or_b32 v132, v3, 6, v132
    v_lshl_or_b32 v132, v14, 4, v132
    v_mul_u32_u24 v134, 48, v18
    s_lshl_b32 s44, s36, 2
    v_add_u32 v133, s44, v134
    v_lshlrev_b32 v137, 13, v21
    v_lshl_or_b32 v137, v18, 2, v137
    v_mov_b32 v135, v29
    s_lshr_b32 s3, s37, 2
    s_lshl_b32 s3, s3, 14
    s_and_b32 s44, s37, 3
    s_lshl_b32 s44, s44, 11
    s_add_u32 s3, s3, s44
    s_lshl_b32 s44, s63, 7
    s_add_u32 s3, s3, s44
    s_add_u32 s3, s3, 32768
    s_cmp_eq_u32 s37, 0
    s_cselect_b32 s60, -1, 0
    s_cmp_lg_u32 s36, 0
    s_cbranch_scc1 L_c1_other
    s_mov_b32 s50, 1048576
L_poll5:
    buffer_load_dwordx4 v[44:47], v57, s[24:27], s49 offen sc1
    s_cmp_eq_u32 s50, 1048512
    s_cbranch_scc1 L_poll5_f
L_poll5_b:
    s_sub_u32 s50, s50, 1
    s_cbranch_scc1 L_poll5_x
    s_waitcnt vmcnt(0)
    v_bitop3_b32 v46, v44, v46, v22 bitop3:0x96
    v_bitop3_b32 v47, v45, v47, v22 bitop3:0x96
    v_or_b32 v46, v46, v47
    v_cmp_ne_u32 vcc, 0, v46
    s_nop 0
    s_and_b64 exec, vcc, vcc
    s_cbranch_scc1 L_poll5
L_poll5_x:
    s_mov_b64 exec, -1
L_c1_go:
    s_barrier
    buffer_load_dwordx4 v[24:27], v9, s[24:27], s48 offen sc1
    buffer_load_dwordx4 v[28:31], v9, s[24:27], s48 offen offset:1024 sc1
    s_cmp_lg_u32 s36, 0
    s_cbranch_scc1 L_c1_wn
    v_max_f32_dpp v46, v44, v44 row_ror:8 row_mask:0xf bank_mask:0xf
    s_nop 1
    v_max_f32_dpp v46, v46, v46 row_ror:4 row_mask:0xf bank_mask:0xf
    s_nop 1
    v_max_f32_dpp v46, v46, v46 row_ror:2 row_mask:0xf bank_mask:0xf
    s_nop 1
    v_max_f32_dpp v46, v46, v46 row_ror:1 row_mask:0xf bank_mask:0xf
    v_mov_b32 v47, v46
    s_nop 1
    v_permlane16_swap_b32 v46, v47
    v_max_f32 v46, v46, v47
    v_mov_b32 v47, v46
    s_nop 1
    v_permlane32_swap_b32 v46, v47
    v_max_f32 v46, v46, v47
    v_sub_f32 v44, v44, v46
    v_exp_f32 v44, v44
    s_nop 0
    v_cvt_pk_bf16_f32 v44, v44, v44
    ds_write_b32 v19, v44 offset:6144
L_c1_wn:
    s_waitcnt lgkmcnt(0)
    s_barrier
    ds_read_b32 v58, v20 offset:6144
    ds_read_b32 v59, v20 offset:6160
    s_waitcnt lgkmcnt(0)
    ds_read_b64_tr_b16 v[80:81], v12 offset:22528
    ds_read_b64_tr_b16 v[82:83], v12 offset:26624
    ds_read_b64_tr_b16 v[84:85], v12 offset:30720
    ds_read_b64_tr_b16 v[86:87], v12 offset:34816
    ds_read_b64_tr_b16 v[88:89], v12 offset:38912
    ds_read_b64_tr_b16 v[90:91], v12 offset:43008
    ds_read_b64_tr_b16 v[92:93], v12 offset:47104
    ds_read_b64_tr_b16 v[94:95], v12 offset:51200
    v_and_b32 v64, v58, v60
    v_and_b32 v65, v58, v61
    v_and_b32 v66, v58, v62
    v_and_b32 v67, v58, v63
    v_and_b32 v68, v59, v60
    v_and_b32 v69, v59, v61
    v_and_b32 v70, v59, v62
    v_and_b32 v71, v59, v63
    s_cbranch_scc1 L_c1_nosum
    v_and_b32 v44, 0xffff0000, v44
    v_mul_f32 v45, v44, v45
    s_nop 1
    v_add_f32_dpp v45, v45, v45 row_ror:8 row_mask:0xf bank_mask:0xf
    s_nop 1
    v_add_f32_dpp v45, v45, v45 row_ror:4 row_mask:0xf bank_mask:0xf
    s_nop 1
    v_add_f32_dpp v45, v45, v45 row_ror:2 row_mask:0xf bank_mask:0xf
    s_nop 1
    v_add_f32_dpp v45, v45, v45 row_ror:1 row_mask:0xf bank_mask:0xf
    v_mov_b32 v47, v45
    s_nop 1
    v_permlane16_swap_b32 v45, v47
    v_add_f32 v45, v45, v47
    v_mov_b32 v47, v45
    s_nop 1
    v_permlane32_swap_b32 v45, v47
    v_add_f32 v45, v45, v47
    v_rcp_f32 v45, v45
    v_lshlrev_b32 v136, 16, v136
    v_and_b32 v136, s60, v136
    ds_write_b32 v135, v45 offset:6400
L_c1_nosum:
    s_mov_b32 s50, 1048576
L_poll6_c:
    s_waitcnt vmcnt(1)
    v_xor_b32 v24, v24, v72
    v_xor_b32 v25, v25, v73
    v_xor_b32 v26, v26, v74
    v_xor_b32 v27, v27, v75
    v_bitop3_b32 v32, v24, v25, v26 bitop3:0x80
    s_nop 0
    v_mfma_f32_16x16x32_bf16 v[112:115], v[64:67], v[24:27], 0
    s_waitcnt vmcnt(0)
    v_xor_b32 v28, v28, v72
    v_xor_b32 v29, v29, v73
    v_xor_b32 v30, v30, v74
    v_xor_b32 v31, v31, v75
    v_bitop3_b32 v32, v32, v27, v28 bitop3:0x80
    s_nop 0
    v_mfma_f32_16x16x32_bf16 v[112:115], v[68:71], v[28:31], v[112:115]
    v_bitop3_b32 v32, v32, v29, v30 bitop3:0x80
    v_bitop3_b32 v32, v32, s43, v31 bitop3:0x80
    v_cmp_ne_u32 vcc, s43, v32
    s_nop 4
    v_cvt_pk_bf16_f32 v112, v112, v113
    v_cvt_pk_bf16_f32 v113, v114, v115
    ds_write_b64 v16, v[112:113] offset:0
    s_cbranch_vccnz L_poll6
L_poll6_x:
    s_waitcnt lgkmcnt(0)
    s_barrier
    ds_read_b128 v[32:35], v15 offset:0
    ds_read_b128 v[36:39], v15 offset:64
    ds_read_b128 v[40:43], v15 offset:128
    ds_read_b128 v[44:47], v15 offset:192
    ds_read_b32 v56, v135 offset:6400
    s_waitcnt lgkmcnt(4)
    v_mfma_f32_16x16x32_bf16 v[116:119], v[32:35], v[80:83], 0
    s_waitcnt lgkmcnt(3)
    v_mfma_f32_16x16x32_bf16 v[116:119], v[36:39], v[84:87], v[116:119]
    s_waitcnt lgkmcnt(2)
    v_mfma_f32_16x16x32_bf16 v[116:119], v[40:43], v[88:91], v[116:119]
    s_waitcnt lgkmcnt(1)
    v_mfma_f32_16x16x32_bf16 v[116:119], v[44:47], v[92:95], v[116:119]
    s_waitcnt lgkmcnt(0)
    s_nop 6
    v_pk_add_f32 v[116:117], v[116:117], v[118:119]
    v_pk_add_f32 v[118:119], v[116:117], v[116:117] op_sel:[0,1] op_sel_hi:[1,0]
    s_nop 1
    v_permlane16_swap_b32 v118, v119
    s_mov_b64 exec, 0xffff
    v_add_f32 v116, v118, v119
    v_mul_f32 v116, v116, v56
    v_bfi_b32 v116, s42, v10, v116
    buffer_store_dword v116, v135, s[24:27], s55 offen
    s_mov_b64 exec, -1
    s_mov_b32 s50, 1048576
    buffer_load_dwordx4 v[140:143], v132, s[24:27], s61 offen sc1
    s_waitcnt vmcnt(2)
    ds_read_b64_tr_b16 v[96:97], v13 offset:32768
    ds_read_b64_tr_b16 v[98:99], v13 offset:33792
    ds_read_b64_tr_b16 v[104:105], v13 offset:32800
    ds_read_b64_tr_b16 v[106:107], v13 offset:33824
    ds_read_b64_tr_b16 v[100:101], v13 offset:34816
    ds_read_b64_tr_b16 v[102:103], v13 offset:35840
    ds_read_b64_tr_b16 v[108:109], v13 offset:34848
    ds_read_b64_tr_b16 v[110:111], v13 offset:35872
    s_waitcnt lgkmcnt(0)
    buffer_load_dwordx4 v[144:147], v132, s[24:27], s61 offen sc1
L_cp:
    s_and_b32 s44, s50, 31
    s_cmp_eq_u32 s44, 1
    s_cbranch_scc1 L_cp_f
L_cp_b:
    s_sub_u32 s50, s50, 1
    s_cbranch_scc1 L_cp_x
    s_waitcnt vmcnt(1)
    v_xor_b32 v120, v140, v10
    v_xor_b32 v121, v141, v10
    v_xor_b32 v122, v142, v10
    v_xor_b32 v123, v143, v10
    buffer_load_dwordx4 v[140:143], v132, s[24:27], s61 offen sc1
    v_or3_b32 v128, v120, v121, v122
    v_bitop3_b32 v128, v128, s42, v123 bitop3:0xc8
    v_cmp_ne_u32 vcc, 0, v128
    v_add_f32_dpp v120, v120, v120 row_ror:4 row_mask:0xf bank_mask:0xf
    v_add_f32_dpp v121, v121, v121 row_ror:4 row_mask:0xf bank_mask:0xf
    v_add_f32_dpp v122, v122, v122 row_ror:4 row_mask:0xf bank_mask:0xf
    v_add_f32_dpp v123, v123, v123 row_ror:4 row_mask:0xf bank_mask:0xf
    v_add_f32_dpp v120, v120, v120 row_ror:8 row_mask:0xf bank_mask:0xf
    v_add_f32_dpp v121, v121, v121 row_ror:8 row_mask:0xf bank_mask:0xf
    v_add_f32_dpp v122, v122, v122 row_ror:8 row_mask:0xf bank_mask:0xf
    v_add_f32_dpp v123, v123, v123 row_ror:8 row_mask:0xf bank_mask:0xf
    s_cbranch_vccz L_cp_x
    s_waitcnt vmcnt(1)
    v_xor_b32 v120, v144, v10
    v_xor_b32 v121, v145, v10
    v_xor_b32 v122, v146, v10
    v_xor_b32 v123, v147, v10
    buffer_load_dwordx4 v[144:147], v132, s[24:27], s61 offen sc1
    v_or3_b32 v128, v120, v121, v122
    v_bitop3_b32 v128, v128, s42, v123 bitop3:0xc8
    v_cmp_ne_u32 vcc, 0, v128
    v_add_f32_dpp v120, v120, v120 row_ror:4 row_mask:0xf bank_mask:0xf
    v_add_f32_dpp v121, v121, v121 row_ror:4 row_mask:0xf bank_mask:0xf
    v_add_f32_dpp v122, v122, v122 row_ror:4 row_mask:0xf bank_mask:0xf
    v_add_f32_dpp v123, v123, v123 row_ror:4 row_mask:0xf bank_mask:0xf
    v_add_f32_dpp v120, v120, v120 row_ror:8 row_mask:0xf bank_mask:0xf
    v_add_f32_dpp v121, v121, v121 row_ror:8 row_mask:0xf bank_mask:0xf
    v_add_f32_dpp v122, v122, v122 row_ror:8 row_mask:0xf bank_mask:0xf
    v_add_f32_dpp v123, v123, v123 row_ror:8 row_mask:0xf bank_mask:0xf
    s_cbranch_vccnz L_cp
L_cp_x:
    v_cvt_pk_bf16_f32 v32, v120, v121
    v_cvt_pk_bf16_f32 v33, v122, v123
    s_nop 0
    v_mov_b32_dpp v34, v32 quad_perm:[1,1,1,1] row_mask:0xf bank_mask:0xf
    v_mov_b32_dpp v35, v33 quad_perm:[1,1,1,1] row_mask:0xf bank_mask:0xf
    v_mov_b32_dpp v36, v32 quad_perm:[2,2,2,2] row_mask:0xf bank_mask:0xf
    v_mov_b32_dpp v37, v33 quad_perm:[2,2,2,2] row_mask:0xf bank_mask:0xf
    v_mfma_f32_16x16x32_bf16 v[48:51], v[32:35], v[96:99], 0
    v_mov_b32_dpp v38, v32 quad_perm:[3,3,3,3] row_mask:0xf bank_mask:0xf
    v_mov_b32_dpp v39, v33 quad_perm:[3,3,3,3] row_mask:0xf bank_mask:0xf
    v_mfma_f32_16x16x32_bf16 v[52:55], v[32:35], v[104:107], 0
    s_nop 0
    v_mfma_f32_16x16x32_bf16 v[48:51], v[36:39], v[100:103], v[48:51]
    v_mfma_f32_16x16x32_bf16 v[52:55], v[36:39], v[108:111], v[52:55]
    s_cmp_lg_u32 s36, 0
    s_mov_b64 exec, 0xffff
    s_nop 4
    ds_write_b32 v133, v48 offset:4096
    ds_write_b32 v133, v52 offset:4864
    s_mov_b64 exec, -1
    s_waitcnt lgkmcnt(0)
    s_barrier
    s_cbranch_scc1 L_c2_done
    ds_read_b128 v[32:35], v134 offset:4096
    ds_read_b128 v[36:39], v134 offset:4112
    s_waitcnt lgkmcnt(1)
    v_pk_add_f32 v[32:33], v[32:33], v[34:35]
    v_add_f32 v32, v32, v136
    s_waitcnt lgkmcnt(0)
    v_pk_add_f32 v[36:37], v[36:37], v[38:39]
    v_pk_add_f32 v[32:33], v[32:33], v[36:37]
    v_add_f32 v32, v32, v33
    v_bfi_b32 v32, s42, v10, v32
    buffer_store_dword v32, v137, s[24:27], s3 offen sc1
    s_waitcnt vmcnt(0)
L_c2_done:
    s_barrier
    s_mov_b64 exec, 0xffff
    buffer_store_dword v116, v135, s[24:27], s55 offen sc1
    buffer_store_dword v116, v135, s[24:27], s57 offen sc1
    s_mov_b64 exec, -1
    s_lshr_b32 s44, s38, 2
    s_xor_b32 s45, s36, 1
    s_or_b32 s44, s44, s45
    s_cmp_lg_u32 s44, 0
    s_cbranch_scc1 L_eref
    s_lshl_b32 s46, s37, 2
    s_add_u32 s46, s46, s38
    s_lshl_b32 s54, s46, 14
    s_add_u32 s54, s54, s100
    s_add_u32 s54, s54, 524288
    s_add_u32 s63, s54, 4096
    v_and_b32 v14, 3, v1
    v_lshrrev_b32 v46, 2, v1
    v_lshlrev_b32 v46, 7, v46
    v_lshl_or_b32 v46, v14, 4, v46
    v_lshl_or_b32 v13, v14, 2, v3
    s_lshl_b32 s44, s46, 5
    v_lshl_add_u32 v8, v13, 1, s44
    v_cmp_gt_u32 vcc, 44, v1
    v_mov_b32 v47, 7340032
    s_nop 0
    v_cndmask_b32 v47, v47, v46, vcc
    v_cndmask_b32 v12, 0, v10, vcc
    s_mov_b32 s52, 0x000f000f
    s_mov_b32 s53, 0x000f000f
    s_waitcnt lgkmcnt(0)
    s_mov_b32 s50, 1048576
L_poll7:
    buffer_load_dwordx4 v[24:27], v46, s[24:27], s54 offen sc1
    buffer_load_dwordx4 v[28:31], v46, s[24:27], s54 offen offset:2048 sc1
    buffer_load_dwordx4 v[32:35], v47, s[24:27], s63 offen sc1
    s_sub_u32 s50, s50, 1
    s_cbranch_scc1 L_poll7_x
    s_waitcnt vmcnt(2)
    v_xor_b32 v24, v24, v10
    v_xor_b32 v25, v25, v10
    v_xor_b32 v26, v26, v10
    v_xor_b32 v27, v27, v10
    v_or3_b32 v40, v24, v25, v26
    s_waitcnt vmcnt(1)
    v_xor_b32 v28, v28, v10
    v_xor_b32 v29, v29, v10
    v_xor_b32 v30, v30, v10
    v_xor_b32 v31, v31, v10
    v_or3_b32 v40, v40, v27, v28
    v_or3_b32 v40, v40, v29, v30
    s_waitcnt vmcnt(0)
    v_xor_b32 v32, v32, v12
    v_xor_b32 v33, v33, v12
    v_xor_b32 v34, v34, v12
    v_xor_b32 v35, v35, v12
    v_or3_b32 v40, v40, v31, v32
    v_or3_b32 v40, v40, v33, v34
    v_bitop3_b32 v40, v40, s42, v35 bitop3:0xc8
    v_cmp_ne_u32 vcc, 0, v40
    v_pk_add_f32 v[24:25], v[24:25], v[28:29]
    v_pk_add_f32 v[26:27], v[26:27], v[30:31]
    v_pk_add_f32 v[24:25], v[24:25], v[32:33]
    v_pk_add_f32 v[26:27], v[26:27], v[34:35]
    s_nop 1
    v_permlane32_swap_b32 v24, v26
    v_permlane32_swap_b32 v25, v27
    s_cbranch_vccnz L_poll7
L_poll7_x:
    v_pk_add_f32 v[24:25], v[24:25], v[26:27]
    s_nop 1
    v_permlane16_swap_b32 v24, v25
    v_add_f32 v24, v24, v25
    s_nop 1
    v_add_f32_dpp v24, v24, v24 row_ror:8 row_mask:0xf bank_mask:0xf
    s_nop 1
    v_add_f32_dpp v24, v24, v24 row_ror:4 row_mask:0xf bank_mask:0xf
    s_mov_b64 exec, s[52:53]
    v_cvt_pk_bf16_f32 v24, v24, v24
    buffer_store_short v24, v8, s[32:35], 0 offen
L_t1b_noep:
L_t1_end:
    s_endpgm
L_eref:
    s_cmp_lg_u32 s45, 0
    s_cbranch_scc1 L_t1_end
    s_and_b32 s45, s38, 3
    s_lshl_b32 s46, s37, 2
    s_add_u32 s46, s46, s45
    s_lshl_b32 s54, s46, 14
    s_sub_u32 s44, s44, 1
    s_mul_i32 s45, s44, 1920
    s_add_u32 s54, s54, s45
    s_add_u32 s54, s54, s100
    s_add_u32 s54, s54, 524288
    s_cmp_eq_u32 s44, 2
    s_cselect_b32 s44, 13, 15
    v_lshlrev_b32 v46, 7, v1
    s_bfm_b64 exec, s44, 0
    s_mov_b32 s50, 1048576
L_poll8:
    buffer_load_dwordx4 v[24:27], v46, s[24:27], s54 offen sc1
    s_sub_u32 s50, s50, 1
    s_cbranch_scc1 L_poll8_x
    s_waitcnt vmcnt(0)
    v_xor_b32 v24, v24, v10
    v_xor_b32 v25, v25, v10
    v_xor_b32 v26, v26, v10
    v_xor_b32 v27, v27, v10
    v_or3_b32 v40, v24, v25, v26
    v_bitop3_b32 v40, v40, s42, v27 bitop3:0xc8
    v_cmp_ne_u32 vcc, 0, v40
    s_nop 0
    s_and_b64 exec, vcc, vcc
    s_cbranch_scc1 L_poll8
L_poll8_x:
    s_mov_b64 exec, -1
    s_endpgm
L_c1_other:
    s_waitcnt vmcnt(0)
    s_branch L_c1_go
L_poll5_f:
    s_mov_b64 s[58:59], exec
    s_mov_b32 exec_lo, -1
    s_mov_b32 exec_hi, 0
    buffer_load_dwordx4 v[148:151], v9, s[24:27], s57 offen sc1
    s_waitcnt vmcnt(0)
    buffer_store_dwordx4 v[148:151], v9, s[24:27], s57 offen sc1
    s_mov_b64 exec, s[58:59]
    s_branch L_poll5_b
L_poll6:
    buffer_load_dwordx4 v[24:27], v9, s[24:27], s48 offen sc1
    buffer_load_dwordx4 v[28:31], v9, s[24:27], s48 offen offset:1024 sc1
    s_sub_u32 s50, s50, 1
    s_cbranch_scc1 L_poll6_x
    s_branch L_poll6_c
L_cp_f:
    s_and_b32 s45, s55, 4294966784
    v_lshlrev_b32 v150, 1, v135
    buffer_load_dwordx2 v[148:149], v150, s[24:27], s45 offen sc1
    s_waitcnt vmcnt(0)
    v_bitop3_b32 v151, v148, v149, v10 bitop3:0x7e
    v_and_b32 v151, 0xff, v151
    v_cmp_eq_u32 vcc, 0, v151
    s_nop 0
    s_and_b64 exec, vcc, vcc
    s_cbranch_scc0 L_cp_g
    buffer_store_dwordx2 v[148:149], v150, s[24:27], s45 offen sc1
L_cp_g:
    s_mov_b64 exec, -1
    s_waitcnt vmcnt(0)
    s_branch L_cp_b
.p2alignl 12, 0xbf810000
L_ffn:
    s_load_dwordx2 s[28:29], s[0:1], 56
    s_mov_b32 s30, 1024
    s_mov_b32 s31, 0x20000
    s_cmp_lt_u32 s38, s63
    s_cbranch_scc1 L_ffn_go
    s_waitcnt vmcnt(0)
L_ffn_go:
    s_barrier
    s_add_u32 s45, s36, 2
    s_cmp_ge_u32 s45, 4
    s_cbranch_scc1 L_nogpost
    s_and_b32 s44, s45, 1
    s_mul_i32 s44, s44, 44032
    s_add_u32 s44, s44, s61
    s_bitcmp1_b32 s45, 1
    s_cbranch_scc1 L_gu9_u
    buffer_load_dword v7, v6, s[8:11], s44 offen
    s_branch L_gu9_e
L_gu9_u:
    buffer_load_dword v7, v6, s[12:15], s44 offen
L_gu9_e:
L_nogpost:
    s_cmp_ge_u32 s38, s63
    s_cbranch_scc1 L_helper
    s_add_u32 s46, s62, s38
    v_lshlrev_b32 v17, 4, v3
    v_and_b32 v18, 31, v1
    v_bfe_u32 v16, v1, 2, 2
    v_and_b32 v14, 3, v1
    v_lshl_or_b32 v4, v3, 4, v16
    v_mul_u32_u24 v4, 2752, v4
    v_lshl_add_u32 v4, v14, 4, v4
    v_lshrrev_b32 v5, 3, v1
    v_and_b32 v63, 7, v1
    v_bfe_u32 v6, v1, 4, 1
    v_lshlrev_b32 v6, 1, v6
    v_xor_b32 v63, v63, v6
    v_lshlrev_b32 v63, 4, v63
    v_lshl_or_b32 v5, v5, 10, v63
    v_xor_b32 v63, 64, v5
    s_mul_i32 s47, s36, 176128
    s_lshl_b32 s44, s46, 6
    s_add_u32 s47, s47, s44
    s_lshl_b32 s49, s46, 15
    s_lshl_b32 s59, s36, 7
    s_add_u32 s49, s49, s59
    s_mul_i32 s51, s36, 12288
    s_add_u32 s51, s51, 22528
    s_mov_b32 m0, s51
    v_lshl_add_u32 v8, v3, 5, s59
    s_waitcnt lgkmcnt(0)
    s_barrier
    s_add_u32 s48, s47, 0
    buffer_load_dwordx4 v4, s[8:11], s48 offen offset:0 lds
    s_add_u32 s48, s47, 9984
    buffer_load_dwordx4 v4, s[8:11], s48 offen offset:1024 lds
    s_add_u32 s48, s47, 19968
    buffer_load_dwordx4 v4, s[8:11], s48 offen offset:2048 lds
    s_add_u32 s48, s47, 29952
    buffer_load_dwordx4 v4, s[8:11], s48 offen offset:3072 lds
    s_add_u32 m0, s51, 4096
    s_barrier
    s_add_u32 s48, s47, 0
    buffer_load_dwordx4 v4, s[12:15], s48 offen offset:0 lds
    s_add_u32 s48, s47, 9984
    buffer_load_dwordx4 v4, s[12:15], s48 offen offset:1024 lds
    s_add_u32 s48, s47, 19968
    buffer_load_dwordx4 v4, s[12:15], s48 offen offset:2048 lds
    s_add_u32 s48, s47, 29952
    buffer_load_dwordx4 v4, s[12:15], s48 offen offset:3072 lds
    buffer_load_dwordx4 v[32:35], v8, s[28:31], 0 offen
    buffer_load_dwordx4 v[36:39], v8, s[28:31], 0 offen offset:16
    s_add_u32 m0, s51, 8192
    s_barrier
    s_add_u32 s48, s49, 0
    buffer_load_dwordx4 v5, s[20:23], s48 offen offset:0 lds
    s_add_u32 s48, s49, 7168
    buffer_load_dwordx4 v63, s[20:23], s48 offen offset:1024 lds
    s_add_u32 s48, s49, 14336
    buffer_load_dwordx4 v5, s[20:23], s48 offen offset:2048 lds
    s_add_u32 s48, s49, 21504
    buffer_load_dwordx4 v63, s[20:23], s48 offen offset:3072 lds
    v_lshrrev_b32 v46, 2, v1
    v_lshlrev_b32 v15, 3, v14
    v_lshl_or_b32 v12, v46, 6, v15
    v_add_u32 v12, s51, v12
    v_lshl_or_b32 v13, v3, 3, v16
    v_lshl_or_b32 v13, v13, 7, v15
    v_bfe_u32 v60, v1, 3, 2
    v_lshl_or_b32 v13, v60, 5, v13
    v_add_u32 v13, s51, v13
    v_xor_b32 v60, 32, v13
    v_xor_b32 v61, 64, v13
    v_xor_b32 v62, 0x60, v13
    v_lshlrev_b32 v19, 11, v16
    v_lshl_or_b32 v19, v3, 6, v19
    v_lshl_or_b32 v19, v14, 4, v19
    s_lshl_b32 s55, s36, 8
    s_add_u32 s55, s55, s100
    s_add_u32 s55, s55, 32768
    s_add_u32 s56, s55, 16384
    v_lshl_or_b32 v20, v3, 5, v15
    v_add_u32 v20, s59, v20
    v_mul_u32_u24 v6, 80, v1
    s_lshl_b32 s44, s36, 3
    v_add_u32 v41, s44, v6
    v_min_u32 v42, 3, v1
    v_lshlrev_b32 v42, 6, v42
    v_add_u32 v42, s44, v42
    v_add_u32 v42, 6144, v42
    v_mov_b32 v43, 0
    v_lshlrev_b32 v44, 1, v18
    v_lshlrev_b32 v45, 2, v2
    v_lshl_or_b32 v45, v3, 14, v45
    s_lshl_b32 s57, s36, 16
    s_lshl_b32 s44, s46, 7
    s_add_u32 s57, s57, s44
    s_add_u32 s57, s57, 524288
    s_add_u32 s62, s57, 8192
    s_mov_b32 s4, 0xffff0000
    s_mov_b32 s5, 0xffff0000
    s_mov_b32 s6, 0
    s_mov_b32 s7, -1
    s_mov_b32 s58, 0xbfb8aa3b
    s_mov_b32 s52, 0xeeeeeeee
    s_mov_b32 s53, 0xeeeeeeee
    s_cmp_eq_u32 s46, 0
    s_cselect_b32 s60, 1.0, 0
    v_lshl_add_u32 v46, v1, 1, s59
    v_and_b32 v47, 7, v1
    v_lshlrev_b32 v47, 3, v47
    v_cmp_eq_u32 vcc, 1, v14
    v_mov_b32 v15, 0x3f803f80
    s_barrier
    s_mov_b32 s50, 1048576
    buffer_load_dwordx4 v[24:27], v19, s[24:27], s55 offen sc1
    buffer_load_dwordx4 v[28:31], v19, s[24:27], s56 offen sc1
    s_waitcnt vmcnt(6)
    v_cndmask_b32 v32, v32, v15, vcc
    v_cndmask_b32 v33, v33, v15, vcc
    v_cndmask_b32 v34, v34, v15, vcc
    v_cndmask_b32 v35, v35, v15, vcc
    v_cndmask_b32 v36, v36, v15, vcc
    v_cndmask_b32 v37, v37, v15, vcc
    v_cndmask_b32 v38, v38, v15, vcc
    v_cndmask_b32 v39, v39, v15, vcc
    ds_read_b64_tr_b16 v[64:65], v12 offset:0
    ds_read_b64_tr_b16 v[66:67], v12 offset:1024
    ds_read_b64_tr_b16 v[68:69], v12 offset:2048
    ds_read_b64_tr_b16 v[70:71], v12 offset:3072
    ds_read_b64_tr_b16 v[72:73], v12 offset:32
    ds_read_b64_tr_b16 v[74:75], v12 offset:1056
    ds_read_b64_tr_b16 v[76:77], v12 offset:2080
    ds_read_b64_tr_b16 v[78:79], v12 offset:3104
    ds_read_b64_tr_b16 v[80:81], v12 offset:4096
    ds_read_b64_tr_b16 v[82:83], v12 offset:5120
    ds_read_b64_tr_b16 v[84:85], v12 offset:6144
    ds_read_b64_tr_b16 v[86:87], v12 offset:7168
    ds_read_b64_tr_b16 v[88:89], v12 offset:4128
    ds_read_b64_tr_b16 v[90:91], v12 offset:5152
    ds_read_b64_tr_b16 v[92:93], v12 offset:6176
    ds_read_b64_tr_b16 v[94:95], v12 offset:7200
    s_waitcnt vmcnt(2)
    ds_read_b64_tr_b16 v[96:97], v13 offset:8192
    ds_read_b64_tr_b16 v[98:99], v13 offset:8704
    ds_read_b64_tr_b16 v[100:101], v60 offset:8192
    ds_read_b64_tr_b16 v[102:103], v60 offset:8704
    ds_read_b64_tr_b16 v[104:105], v61 offset:8192
    ds_read_b64_tr_b16 v[106:107], v61 offset:8704
    ds_read_b64_tr_b16 v[108:109], v62 offset:8192
    ds_read_b64_tr_b16 v[110:111], v62 offset:8704
    v_mov_b32 v15, 0x3727c5ac
    s_mov_b32 s63, 0x3b000000
L_poll10_w:
    s_sub_u32 s50, s50, 1
    s_cbranch_scc1 L_poll10_x
    s_waitcnt vmcnt(1)
    v_xor_b32 v24, v24, v10
    v_xor_b32 v25, v25, v10
    v_xor_b32 v26, v26, v10
    v_xor_b32 v27, v27, v10
    v_or3_b32 v40, v24, v25, v26
    s_waitcnt vmcnt(0)
    v_xor_b32 v28, v28, v10
    v_xor_b32 v29, v29, v10
    v_xor_b32 v30, v30, v10
    v_xor_b32 v31, v31, v10
    v_or3_b32 v40, v40, v27, v28
    v_or3_b32 v40, v40, v29, v30
    v_bitop3_b32 v40, v40, s42, v31 bitop3:0xc8
    v_cmp_ne_u32 vcc, 0, v40
    v_pk_add_f32 v[24:25], v[24:25], v[28:29]
    v_pk_add_f32 v[26:27], v[26:27], v[30:31]
    s_nop 0
    v_add_f32_dpp v24, v24, v24 row_ror:4 row_mask:0xf bank_mask:0xf
    v_add_f32_dpp v25, v25, v25 row_ror:4 row_mask:0xf bank_mask:0xf
    v_add_f32_dpp v26, v26, v26 row_ror:4 row_mask:0xf bank_mask:0xf
    v_add_f32_dpp v27, v27, v27 row_ror:4 row_mask:0xf bank_mask:0xf
    s_cbranch_vccnz L_poll10
L_poll10_x:
    v_add_f32_dpp v24, v24, v24 row_ror:8 row_mask:0xf bank_mask:0xf
    v_add_f32_dpp v25, v25, v25 row_ror:8 row_mask:0xf bank_mask:0xf
    v_add_f32_dpp v26, v26, v26 row_ror:8 row_mask:0xf bank_mask:0xf
    v_add_f32_dpp v27, v27, v27 row_ror:8 row_mask:0xf bank_mask:0xf
    s_mov_b64 vcc, s[52:53]
    v_cvt_pk_bf16_f32 v28, v24, v25
    v_cvt_pk_bf16_f32 v29, v26, v27
    v_cndmask_b32 v32, v28, v32, vcc
    v_cndmask_b32 v33, v29, v33, vcc
    v_cndmask_b32_dpp v34, v28, v34, vcc quad_perm:[1,1,1,1] row_mask:0xf bank_mask:0xf
    v_cndmask_b32_dpp v35, v29, v35, vcc quad_perm:[1,1,1,1] row_mask:0xf bank_mask:0xf
    v_cndmask_b32_dpp v36, v28, v36, vcc quad_perm:[2,2,2,2] row_mask:0xf bank_mask:0xf
    v_cndmask_b32_dpp v37, v29, v37, vcc quad_perm:[2,2,2,2] row_mask:0xf bank_mask:0xf
    s_waitcnt lgkmcnt(0)
    v_mfma_f32_16x16x32_bf16 v[128:131], v[32:35], v[32:35], 0
    v_cndmask_b32_dpp v38, v28, v38, vcc quad_perm:[3,3,3,3] row_mask:0xf bank_mask:0xf
    v_mfma_f32_16x16x32_bf16 v[112:115], v[32:35], v[64:67], 0
    v_cndmask_b32_dpp v39, v29, v39, vcc quad_perm:[3,3,3,3] row_mask:0xf bank_mask:0xf
    v_mfma_f32_16x16x32_bf16 v[116:119], v[32:35], v[72:75], 0
    v_mfma_f32_16x16x32_bf16 v[120:123], v[32:35], v[80:83], 0
    v_mfma_f32_16x16x32_bf16 v[124:127], v[32:35], v[88:91], 0
    v_mfma_f32_16x16x32_bf16 v[128:131], v[36:39], v[36:39], v[128:131]
    v_mfma_f32_16x16x32_bf16 v[112:115], v[36:39], v[68:71], v[112:115]
    v_mfma_f32_16x16x32_bf16 v[116:119], v[36:39], v[76:79], v[116:119]
    v_mfma_f32_16x16x32_bf16 v[120:123], v[36:39], v[84:87], v[120:123]
    v_mfma_f32_16x16x32_bf16 v[124:127], v[36:39], v[92:95], v[124:127]
    ds_write_b64 v20, v[28:29] offset:6400
    s_cmp_lg_u32 s36, 0
    s_nop 1
    ds_write_b64 v42, v[128:129]
    s_nop 0
    v_cndmask_b32 v112, v112, v116, s[4:5]
    v_cndmask_b32 v113, v113, v117, s[4:5]
    v_cndmask_b32 v120, v120, v124, s[4:5]
    v_cndmask_b32 v121, v121, v125, s[4:5]
    v_cndmask_b32 v112, v112, v120, s[6:7]
    v_cndmask_b32 v113, v113, v121, s[6:7]
    ds_write_b64 v41, v[112:113] offset:0
    s_waitcnt lgkmcnt(0)
    s_barrier
    s_cbranch_scc1 L_d_other
    ds_read_b64 v[48:49], v47 offset:6144
    ds_read_b128 v[112:115], v6 offset:0
    ds_read_b128 v[116:119], v6 offset:16
    ds_read_b128 v[120:123], v6 offset:32
    ds_read_b128 v[124:127], v6 offset:48
    ds_read_u16 v132, v46 offset:6400
    s_waitcnt lgkmcnt(5)
    v_add_f32_dpp v49, v49, v49 row_ror:4 row_mask:0xf bank_mask:0xf
    v_add_f32_dpp v48, v48, v48 row_ror:4 row_mask:0xf bank_mask:0xf
    s_waitcnt lgkmcnt(3)
    v_add_f32_dpp v49, v49, v49 row_ror:2 row_mask:0xf bank_mask:0xf
    v_add_f32_dpp v48, v48, v48 row_ror:2 row_mask:0xf bank_mask:0xf
    v_pk_add_f32 v[112:113], v[112:113], v[114:115]
    v_add_f32_dpp v49, v49, v49 row_ror:1 row_mask:0xf bank_mask:0xf
    v_add_f32_dpp v48, v48, v48 row_ror:1 row_mask:0xf bank_mask:0xf
    v_mul_f32 v50, 0x3b000000, v49
    v_fma_f32 v51, -v50, v49, v48
    v_max_f32 v51, 0, v51
    v_fma_f32 v52, v51, s63, v15
    v_rsq_f32 v52, v52
    s_waitcnt lgkmcnt(1)
    v_pk_add_f32 v[116:117], v[116:117], v[118:119]
    v_pk_add_f32 v[120:121], v[120:121], v[122:123]
    v_pk_add_f32 v[124:125], v[124:125], v[126:127]
    v_pk_add_f32 v[112:113], v[112:113], v[116:117]
    v_pk_add_f32 v[120:121], v[120:121], v[124:125]
    v_pk_add_f32 v[112:113], v[112:113], v[120:121]
    v_fma_f32 v112, -v50, v113, v112
    v_mul_f32 v112, v112, v52
    v_mul_f32 v114, s58, v112
    v_mov_b32 v113, v112
    v_exp_f32 v114, v114
    s_nop 0
    v_permlane32_swap_b32 v112, v113
    v_add_f32 v114, 1.0, v114
    v_rcp_f32 v114, v114
    v_mul_f32 v112, v112, v113
    v_mul_f32 v112, v112, v114
    v_cvt_pk_bf16_f32 v112, v112, v112
    s_mov_b32 exec_hi, 0
    ds_write_b16 v44, v112 offset:7424
    s_mov_b32 exec_hi, -1
    s_waitcnt lgkmcnt(0)
L_d_act:
    s_barrier
    ds_read_b128 v[24:27], v17 offset:7424
    ds_read_b96 v[28:30], v43 offset:7488
    v_lshlrev_b32 v132, 16, v132
    s_cmp_lg_u32 s2, 128
    s_waitcnt lgkmcnt(1)
    v_mfma_f32_16x16x32_bf16 v[112:115], v[24:27], v[96:99], 0
    v_mfma_f32_16x16x32_bf16 v[116:119], v[24:27], v[100:103], 0
    v_mfma_f32_16x16x32_bf16 v[120:123], v[24:27], v[104:107], 0
    v_mfma_f32_16x16x32_bf16 v[124:127], v[24:27], v[108:111], 0
    s_waitcnt lgkmcnt(0)
    v_fma_f32 v132, v132, v29, v30
    s_nop 3
    v_cndmask_b32 v112, v112, v116, s[4:5]
    s_nop 0
    v_cndmask_b32 v120, v120, v124, s[4:5]
    v_cndmask_b32 v112, v112, v120, s[6:7]
    v_fma_f32 v112, v112, v28, v132
    v_bfi_b32 v112, s42, v10, v112
    buffer_store_dword v112, v45, s[24:27], s57 offen sc1
    buffer_store_dword v112, v45, s[24:27], s62 offen sc1
    s_cbranch_scc1 L_ffn_end
    s_cmp_lg_u32 s36, 0
    s_cbranch_scc1 L_ffn_end
    s_mov_b64 exec, 1
    buffer_store_dword v22, v9, s[24:27], 0 offen offset:0 sc1
L_ffn_end:
    s_endpgm
L_poll10:
    buffer_load_dwordx4 v[24:27], v19, s[24:27], s55 offen sc1
    buffer_load_dwordx4 v[28:31], v19, s[24:27], s56 offen sc1
    s_branch L_poll10_w
L_d_other:
    s_cmp_lg_u32 s36, 1
    s_cbranch_scc1 L_d_rest
    ds_read_b64 v[48:49], v47 offset:6144
    ds_read_b64 v[50:51], v47 offset:6272
    s_waitcnt lgkmcnt(0)
    v_add_f32_dpp v48, v48, v48 row_ror:4 row_mask:0xf bank_mask:0xf
    v_add_f32_dpp v49, v49, v49 row_ror:4 row_mask:0xf bank_mask:0xf
    v_add_f32_dpp v50, v50, v50 row_ror:4 row_mask:0xf bank_mask:0xf
    v_add_f32_dpp v51, v51, v51 row_ror:4 row_mask:0xf bank_mask:0xf
    v_add_f32_dpp v48, v48, v48 row_ror:2 row_mask:0xf bank_mask:0xf
    v_add_f32_dpp v49, v49, v49 row_ror:2 row_mask:0xf bank_mask:0xf
    v_add_f32_dpp v50, v50, v50 row_ror:2 row_mask:0xf bank_mask:0xf
    v_add_f32_dpp v51, v51, v51 row_ror:2 row_mask:0xf bank_mask:0xf
    v_add_f32_dpp v48, v48, v48 row_ror:1 row_mask:0xf bank_mask:0xf
    v_add_f32_dpp v49, v49, v49 row_ror:1 row_mask:0xf bank_mask:0xf
    v_add_f32_dpp v50, v50, v50 row_ror:1 row_mask:0xf bank_mask:0xf
    v_add_f32_dpp v51, v51, v51 row_ror:1 row_mask:0xf bank_mask:0xf
    v_mul_f32 v49, 0x3b000000, v49
    v_mul_f32 v48, 0x3b000000, v48
    v_fma_f32 v48, -v49, v49, v48
    v_max_f32 v48, 0, v48
    v_add_f32 v48, 0x3727c5ac, v48
    v_rsq_f32 v48, v48
    v_fma_f32 v50, -v49, v51, v50
    v_mul_f32 v50, v50, v48
    v_mul_f32 v50, s58, v50
    v_exp_f32 v50, v50
    v_add_f32 v53, 1.0, v48
    v_mul_f32 v54, v49, v48
    v_add_f32 v50, 1.0, v50
    v_rcp_f32 v52, v50
    v_mul_f32 v53, s60, v53
    v_mul_f32 v54, s60, v54
    v_sub_f32 v54, 0, v54
    s_mov_b64 exec, 1
    ds_write_b96 v43, v[52:54] offset:7488
    s_mov_b64 exec, -1
L_d_rest:
    ds_read_u16 v132, v46 offset:6400
    s_waitcnt lgkmcnt(0)
    s_branch L_d_act
L_helper:
    s_cmp_lt_u32 s38, 6
    s_cbranch_scc1 L_ffn_end
    s_cmp_lt_u32 s36, 4
    s_cbranch_scc1 L_ffn_end
    s_lshl_b32 s44, s38, 2
    s_add_u32 s44, s44, s36
    s_sub_u32 s44, s44, 28
    s_cmp_eq_u32 s63, 6
    s_cselect_b32 s45, 39, 32
    s_mul_i32 s44, s44, s45
    s_lshl_b32 s44, s44, 7
    s_bfm_b64 exec, s45, 0
    s_lshl_b32 s45, s62, 15
    s_add_u32 s44, s44, s45
    buffer_load_dword v24, v8, s[20:23], s44 offen
    s_mov_b64 exec, -1
    s_cmp_lt_u32 s38, 14
    s_cbranch_scc1 L_ffn_end
    s_cmp_lg_u32 s36, 7
    s_cbranch_scc1 L_ffn_end
    s_and_b32 s44, s38, 1
    s_lshl_b32 s44, s44, 14
    s_add_u32 s44, s44, s100
    s_add_u32 s44, s44, 32768
    buffer_load_dword v26, v8, s[24:27], s44 offen sc1
    s_mov_b64 exec, 0xff
    s_waitcnt lgkmcnt(0)
    buffer_load_dword v25, v8, s[28:31], 0 offen
    s_endpgm
L_code_end:
.section .rodata,"a"
.p2align 6
.amdhsa_kernel sequential_preLN__compressed_kv_cla__moe_arch_mod__decode_kernel
  .amdhsa_next_free_vgpr 256
  .amdhsa_next_free_sgpr 102
  .amdhsa_accum_offset 256
  .amdhsa_group_segment_fixed_size 0
  .amdhsa_kernarg_size 112
  .amdhsa_user_sgpr_count 2
  .amdhsa_user_sgpr_kernarg_segment_ptr 1
  .amdhsa_system_sgpr_workgroup_id_x 1
.end_amdhsa_kernel
```
